```python
import torch

def _softmax(x, axis=-1):
    return torch.softmax(x, dim=axis)
def _gelu(x):
    return torch.nn.functional.gelu(x, approximate="tanh")
def _silu(x):
    return torch.nn.functional.silu(x)
def _sigmoid(x):
    return torch.sigmoid(x)
def _layernorm(x, axis=-1, eps=1e-5):
    m = x.mean(dim=axis, keepdim=True)
    v = x.var(dim=axis, keepdim=True, unbiased=False)
    return (x - m) / torch.sqrt(v + eps)
def _scatter_add(tgt, idx, src, axis=0):
    return tgt.clone().index_add_(axis, idx, src)
def _segment_sum(src, seg, n):
    out = torch.zeros((n,) + src.shape[1:], dtype=src.dtype)
    return out.index_add_(0, seg, src)
def _pad(x, pw):
    flat = tuple(v for pair in reversed(pw) for v in pair)
    return torch.nn.functional.pad(x, flat)

kernel_name = 'standalone__gqa_softmax__sampling'

def setup_inputs():

    _w = (lambda a: (lambda t: t.to(torch.bfloat16) if t.is_floating_point() else t)(torch.as_tensor(a)))
    B, Hq, Hkv, Sq, Sk, D = 8, 16, 8, 8, 8192, 256
    return {
        "q": _w((lambda *s: torch.randn(*s, dtype=torch.bfloat16) * 0.8)(B, Hq, Sq, D)),
        "k": _w((lambda *s: torch.randn(*s, dtype=torch.bfloat16) * 0.8)(B, Hkv, Sk, D)),
        "v": _w((lambda *s: torch.randn(*s, dtype=torch.bfloat16) * 0.05)(B, Hkv, Sk, D)),
    }

def reference(q, k, v):
    B, Hq, Sq, D = q.shape
    Hkv = k.shape[1]
    rep = Hq // Hkv
    k = (lambda x, n, axis: torch.repeat_interleave(x, n, dim=axis))(k, rep, axis=1)
    v = (lambda x, n, axis: torch.repeat_interleave(x, n, dim=axis))(v, rep, axis=1)
    scale = D ** -0.5
    scores = torch.einsum("bhqd,bhkd->bhqk", q, k) * scale
    p = _softmax(scores, axis=-1)
    return torch.einsum("bhqk,bhkd->bhqd", p, v)
```

```asm
; @launch grid=(256,1,1) block=(256,1,1) lds=78144
.amdgcn_target "amdgcn-amd-amdhsa--gfx950"
.text
.globl standalone__gqa_softmax__sampling_kernel
.p2align 8
.type standalone__gqa_softmax__sampling_kernel,@function
standalone__gqa_softmax__sampling_kernel:
s_cmp_ge_u32 s2, 256
s_cbranch_scc1 L_end
s_load_dwordx8 s[4:11], s[0:1], 0
s_load_dwordx4 s[12:15], s[0:1], 32
s_mov_b32 s80, s2
s_mov_b32 s3, 0
s_bfe_u32 s51, s2, 0x10000
s_or_b32 s3, s3, s51
s_bfe_u32 s51, s2, 0x10001
s_lshl_b32 s51, s51, 3
s_or_b32 s3, s3, s51
s_bfe_u32 s51, s2, 0x10002
s_lshl_b32 s51, s51, 1
s_or_b32 s3, s3, s51
s_bfe_u32 s51, s2, 0x10003
s_lshl_b32 s51, s51, 7
s_or_b32 s3, s3, s51
s_bfe_u32 s51, s2, 0x10004
s_lshl_b32 s51, s51, 2
s_or_b32 s3, s3, s51
s_bfe_u32 s51, s2, 0x10005
s_lshl_b32 s51, s51, 4
s_or_b32 s3, s3, s51
s_bfe_u32 s51, s2, 0x10006
s_lshl_b32 s51, s51, 6
s_or_b32 s3, s3, s51
s_bfe_u32 s51, s2, 0x10007
s_lshl_b32 s51, s51, 5
s_or_b32 s3, s3, s51
s_mov_b32 s2, s3
v_lshrrev_b32 v1, 6, v0
v_and_b32 v28, 63, v0
v_readfirstlane_b32 s40, v1
s_lshr_b32 s41, s2, 2
s_and_b32 s42, s2, 3
v_lshrrev_b32 v12, 5, v28
v_xor_b32 v1, v12, v28
v_lshlrev_b32 v1, 4, v1
s_lshl_b32 s49, s41, 22
s_mul_i32 s59, s40, 16896
s_mov_b32 s43, 0
s_mov_b32 s58, 0
s_bitcmp1_b32 s40, 0
s_cselect_b32 s51, 0x8000, 0
s_xor_b32 s58, s58, s51
s_bitcmp1_b32 s40, 1
s_cselect_b32 s51, 0x2de000, 0
s_xor_b32 s58, s58, s51
s_bitcmp1_b32 s2, 0
s_cselect_b32 s51, 0x45000, 0
s_xor_b32 s58, s58, s51
s_bitcmp1_b32 s2, 1
s_cselect_b32 s51, 0x17c000, 0
s_xor_b32 s58, s58, s51
s_bitcmp1_b32 s2, 2
s_cselect_b32 s51, 0x20c800, 0
s_xor_b32 s58, s58, s51
s_bitcmp1_b32 s2, 3
s_cselect_b32 s51, 0x33d000, 0
s_xor_b32 s58, s58, s51
s_bitcmp1_b32 s2, 4
s_cselect_b32 s51, 0x2d7000, 0
s_xor_b32 s58, s58, s51
s_bitcmp1_b32 s2, 5
s_cselect_b32 s51, 0xef000, 0
s_xor_b32 s58, s58, s51
s_bitcmp1_b32 s2, 6
s_cselect_b32 s51, 0x216000, 0
s_xor_b32 s58, s58, s51
s_bitcmp1_b32 s2, 7
s_cselect_b32 s51, 0x3d4800, 0
s_xor_b32 s58, s58, s51
s_lshl_b32 s50, s41, 13
s_mov_b32 s64, s58
s_bitcmp1_b32 s43, 0
s_cselect_b32 s65, 0x96000, 0
s_xor_b32 s64, s64, s65
s_bitcmp1_b32 s43, 1
s_cselect_b32 s65, 0x38000, 0
s_xor_b32 s64, s64, s65
s_bitcmp1_b32 s43, 2
s_cselect_b32 s65, 0x96800, 0
s_xor_b32 s64, s64, s65
s_bitcmp1_b32 s43, 3
s_cselect_b32 s65, 0x94800, 0
s_xor_b32 s64, s64, s65
s_xor_b32 s65, s64, 0x2a0000
s_xor_b32 s66, s64, 0x212000
s_xor_b32 s67, s65, 0x212000
s_xor_b32 s68, s64, 0x202000
s_xor_b32 s69, s65, 0x202000
s_xor_b32 s70, s66, 0x202000
s_xor_b32 s71, s67, 0x202000
s_add_u32 s43, s43, 1
s_waitcnt lgkmcnt(0)
s_add_u32 s16, s6, s49
s_addc_u32 s17, s7, 0
s_mov_b32 s18, 4194304
s_mov_b32 s19, 0x20000
s_add_u32 m0, s59, 0
s_nop 0
buffer_load_dwordx4 v1, s[16:19], s64 offen offset:0 nt lds
s_add_u32 m0, s59, 2112
s_nop 0
buffer_load_dwordx4 v1, s[16:19], s65 offen offset:0 nt lds
s_add_u32 m0, s59, 32
s_nop 0
buffer_load_dwordx4 v1, s[16:19], s64 offen offset:1024 nt lds
s_add_u32 m0, s59, 2144
s_nop 0
buffer_load_dwordx4 v1, s[16:19], s65 offen offset:1024 nt lds
s_add_u32 m0, s59, 4224
s_nop 0
buffer_load_dwordx4 v1, s[16:19], s66 offen offset:0 nt lds
s_add_u32 s24, s4, s50
s_addc_u32 s25, s5, 0
s_mov_b32 s26, 8192
s_mov_b32 s27, 0x20000
s_mul_i32 s51, s40, 2112
s_add_u32 m0, s51, 67584
s_lshl_b32 s60, s40, 11
buffer_load_dwordx4 v1, s[24:27], s60 offen lds
s_add_u32 m0, s51, 67616
s_nop 0
buffer_load_dwordx4 v1, s[24:27], s60 offen offset:1024 lds
s_mov_b32 s32, s14
s_mov_b32 s33, s15
s_mov_b32 s34, 16777216
s_mov_b32 s35, 0x20000
s_lshl_b32 s78, s41, 14
s_add_u32 s78, s78, 4195200
v_mov_b32 v246, 5275648
v_writelane_b32 v246, s78, 0
s_mov_b64 exec, 3
buffer_load_dword v242, v246, s[32:35], 0 offen sc1
s_mov_b64 exec, -1
s_lshl_b32 s51, s41, 4
s_add_u32 s51, s51, s40
s_xor_b32 s72, s42, 0
s_lshl_b32 s72, s72, 2
s_add_u32 s72, s72, s51
s_lshl_b32 s52, s72, 11
s_lshl_b32 s72, s72, 10
s_add_u32 s72, s72, 4194304
s_xor_b32 s73, s42, 1
s_lshl_b32 s73, s73, 2
s_add_u32 s73, s73, s51
s_lshl_b32 s53, s73, 11
s_lshl_b32 s73, s73, 10
s_add_u32 s73, s73, 4194304
s_xor_b32 s74, s42, 2
s_lshl_b32 s74, s74, 2
s_add_u32 s74, s74, s51
s_lshl_b32 s54, s74, 11
s_lshl_b32 s74, s74, 10
s_add_u32 s74, s74, 4194304
s_xor_b32 s75, s42, 3
s_lshl_b32 s75, s75, 2
s_add_u32 s75, s75, s51
s_lshl_b32 s55, s75, 11
s_lshl_b32 s75, s75, 10
s_add_u32 s75, s75, 4194304
v_lshlrev_b32 v252, 4, v28
v_lshlrev_b32 v253, 3, v28
v_mul_u32_u24 v249, 12, v28
s_cmp_eq_u32 s40, 0
s_cselect_b32 s51, 0, 16
s_add_u32 s51, s51, 78080
v_mov_b32 v250, s51
v_mov_b32 v251, 78080
s_lshl_b32 s51, s41, 2
s_cmp_eq_u32 s40, 0
s_cselect_b32 s51, s51, 0x1000
v_mov_b32 v241, s51
s_add_u32 s28, s10, s50
s_addc_u32 s29, s11, 0
s_mov_b32 s30, 8192
s_mov_b32 s31, 0x20000
s_mov_b32 s36, s12
s_mov_b32 s37, s13
s_mov_b32 s38, 256
s_mov_b32 s39, 0x20000
s_mov_b32 s46, 0x3db8aa3b
s_mov_b32 s47, 0x05040100
s_mov_b32 s48, 0x07060302
v_mov_b32 v8, 0xff7fffff
v_mov_b32 v9, 0
v_mov_b32 v11, 0
v_mov_b32 v240, 1
s_mov_b32 s79, 0x40000
s_add_u32 s20, s8, s49
s_addc_u32 s21, s9, 0
s_mov_b32 s22, 4194304
s_mov_b32 s23, 0x20000
v_and_b32 v12, 15, v28
v_lshrrev_b32 v13, 4, v28
v_lshlrev_b32 v14, 2, v13
s_movk_i32 s51, 0x3102
v_lshrrev_b32 v14, v14, s51
v_and_b32 v14, 3, v14
v_lshlrev_b32 v2, 9, v14
v_lshl_add_u32 v2, v12, 4, v2
v_lshlrev_b32 v254, 9, v12
v_lshl_add_u32 v254, v13, 6, v254
s_lshr_b32 s56, s40, 1
s_lshl_b32 s56, s56, 8
s_and_b32 s51, s40, 1
s_lshl_b32 s51, s51, 5
s_add_u32 s56, s56, s51
v_lshrrev_b32 v13, 4, v28
s_movk_i32 s51, 0x3102
v_bfe_u32 v14, v28, 2, 2
v_lshlrev_b32 v14, 2, v14
v_lshrrev_b32 v14, v14, s51
v_and_b32 v14, 3, v14
v_and_b32 v12, 3, v28
v_lshl_add_u32 v12, v12, 2, v14
v_lshrrev_b32 v14, 1, v12
v_mul_u32_u24 v14, 1056, v14
v_and_b32 v12, 1, v12
v_lshl_add_u32 v14, v12, 9, v14
v_xor_b32 v12, v13, v12
v_lshl_add_u32 v14, v12, 4, v14
v_add_u32 v4, s59, v14
v_add_u32 v5, 64, v4
v_add_u32 v6, 128, v4
v_add_u32 v7, 192, v4
v_bfe_u32 v14, v28, 1, 3
v_mul_u32_u24 v14, 1056, v14
v_and_b32 v12, 1, v28
v_lshl_add_u32 v14, v12, 9, v14
v_xor_b32 v12, v13, v12
v_lshl_add_u32 v14, v12, 4, v14
v_add_u32 v29, 67584, v14
v_mov_b32 v48, 0
v_mov_b32 v49, 0
v_mov_b32 v50, 0
v_mov_b32 v51, 0
v_mov_b32 v52, 0
v_mov_b32 v53, 0
v_mov_b32 v54, 0
v_mov_b32 v55, 0
v_mov_b32 v56, 0
v_mov_b32 v57, 0
v_mov_b32 v58, 0
v_mov_b32 v59, 0
v_mov_b32 v60, 0
v_mov_b32 v61, 0
v_mov_b32 v62, 0
v_mov_b32 v63, 0
v_mov_b32 v64, 0
v_mov_b32 v65, 0
v_mov_b32 v66, 0
v_mov_b32 v67, 0
v_mov_b32 v68, 0
v_mov_b32 v69, 0
v_mov_b32 v70, 0
v_mov_b32 v71, 0
v_mov_b32 v72, 0
v_mov_b32 v73, 0
v_mov_b32 v74, 0
v_mov_b32 v75, 0
v_mov_b32 v76, 0
v_mov_b32 v77, 0
v_mov_b32 v78, 0
v_mov_b32 v79, 0
v_mov_b32 v80, 0
v_mov_b32 v81, 0
v_mov_b32 v82, 0
v_mov_b32 v83, 0
v_mov_b32 v84, 0
v_mov_b32 v85, 0
v_mov_b32 v86, 0
v_mov_b32 v87, 0
v_mov_b32 v88, 0
v_mov_b32 v89, 0
v_mov_b32 v90, 0
v_mov_b32 v91, 0
v_mov_b32 v92, 0
v_mov_b32 v93, 0
v_mov_b32 v94, 0
v_mov_b32 v95, 0
v_mov_b32 v96, 0
v_mov_b32 v97, 0
v_mov_b32 v98, 0
v_mov_b32 v99, 0
v_mov_b32 v100, 0
v_mov_b32 v101, 0
v_mov_b32 v102, 0
v_mov_b32 v103, 0
v_mov_b32 v104, 0
v_mov_b32 v105, 0
v_mov_b32 v106, 0
v_mov_b32 v107, 0
v_mov_b32 v108, 0
v_mov_b32 v109, 0
v_mov_b32 v110, 0
v_mov_b32 v111, 0
s_add_u32 m0, s59, 6336
s_waitcnt vmcnt(7)
buffer_load_dwordx4 v1, s[16:19], s67 offen offset:0 nt lds
s_add_u32 m0, s59, 4256
s_waitcnt vmcnt(7)
buffer_load_dwordx4 v1, s[16:19], s66 offen offset:1024 nt lds
s_add_u32 m0, s59, 6368
s_waitcnt vmcnt(7)
buffer_load_dwordx4 v1, s[16:19], s67 offen offset:1024 nt lds
s_add_u32 m0, s59, 8448
s_waitcnt vmcnt(7)
buffer_load_dwordx4 v1, s[16:19], s68 offen offset:0 nt lds
s_add_u32 m0, s59, 10560
s_waitcnt vmcnt(7)
buffer_load_dwordx4 v1, s[16:19], s69 offen offset:0 nt lds
s_add_u32 m0, s59, 8480
s_waitcnt vmcnt(4)
buffer_load_dwordx4 v1, s[16:19], s68 offen offset:1024 nt lds
s_add_u32 m0, s59, 10592
s_waitcnt vmcnt(4)
buffer_load_dwordx4 v1, s[16:19], s69 offen offset:1024 nt lds
v_mov_b32 v243, 0
ds_write_b32 v250, v243 offset:8
s_waitcnt lgkmcnt(0)
v_readfirstlane_b32 s57, v242
v_readlane_b32 s81, v242, 1
s_barrier
s_add_u32 s57, s57, 1
s_add_u32 s81, s81, 128
ds_read_b128 a[0:3], v29 offset:0
ds_read_b128 a[4:7], v29 offset:64
ds_read_b128 a[8:11], v29 offset:128
ds_read_b128 a[12:15], v29 offset:192
ds_read_b128 a[16:19], v29 offset:256
ds_read_b128 a[20:23], v29 offset:320
ds_read_b128 a[24:27], v29 offset:384
ds_read_b128 a[28:31], v29 offset:448
s_mov_b32 s26, s81
s_mov_b32 s51, 5242880
s_cmp_eq_u32 s40, 0
s_cselect_b32 s51, s51, 0x2000000
s_lshl_b32 s25, s80, 7
s_add_u32 s25, s25, s51
s_mov_b32 s24, 0
s_mov_b64 vcc, 0
v_mov_b32 v248, 0
s_and_b32 s50, s80, 7
s_lshl_b32 s50, s50, 7
s_add_u32 s50, s50, s51
v_lshl_add_u32 v248, v28, 2, s50
s_lshr_b32 s25, s80, 3
s_lshl_b32 s25, s25, 2
s_add_u32 s25, s25, s50
s_getreg_b32 s50, hwreg(HW_REG_XCC_ID, 0, 3)
s_lshr_b32 s50, 85, s50
s_bitcmp1_b32 s50, 0
s_cselect_b32 s83, 23, 27
s_cselect_b32 s82, 27, 23
s_add_u32 m0, s59, 12672
s_waitcnt vmcnt(4)
buffer_load_dwordx4 v1, s[16:19], s70 offen offset:0 nt lds
s_add_u32 m0, s59, 14784
s_waitcnt vmcnt(4)
buffer_load_dwordx4 v1, s[16:19], s71 offen offset:0 nt lds
s_add_u32 m0, s59, 12704
s_waitcnt vmcnt(4)
buffer_load_dwordx4 v1, s[16:19], s70 offen offset:1024 nt lds
s_add_u32 m0, s59, 14816
s_waitcnt vmcnt(4)
buffer_load_dwordx4 v1, s[16:19], s71 offen offset:1024 nt lds
s_waitcnt vmcnt(4)
buffer_load_dwordx4 v[112:115], v2, s[20:23], s64 offen offset:0 nt
s_waitcnt vmcnt(4)
buffer_load_dwordx4 v[116:119], v2, s[20:23], s65 offen offset:0 nt
s_waitcnt vmcnt(4)
buffer_load_dwordx4 v[144:147], v2, s[20:23], s64 offen offset:256 nt
s_waitcnt vmcnt(4)
buffer_load_dwordx4 v[148:151], v2, s[20:23], s65 offen offset:256 nt
s_waitcnt vmcnt(4)
buffer_load_dwordx4 v[120:123], v2, s[20:23], s66 offen offset:0 nt
ds_read_b128 v[176:179], v4 offset:0
ds_read_b128 v[180:183], v5 offset:0
ds_read_b128 v[184:187], v6 offset:0
ds_read_b128 v[188:191], v7 offset:0
ds_read_b128 v[192:195], v4 offset:256
ds_read_b128 v[196:199], v5 offset:256
ds_read_b128 v[200:203], v6 offset:256
ds_read_b128 v[204:207], v7 offset:256
s_waitcnt vmcnt(4)
buffer_load_dwordx4 v[124:127], v2, s[20:23], s67 offen offset:0 nt
ds_read_b128 v[208:211], v4 offset:8448
ds_read_b128 v[212:215], v5 offset:8448
ds_read_b128 v[216:219], v6 offset:8448
ds_read_b128 v[220:223], v7 offset:8448
ds_read_b128 v[224:227], v4 offset:8704
ds_read_b128 v[228:231], v5 offset:8704
ds_read_b128 v[232:235], v6 offset:8704
ds_read_b128 v[236:239], v7 offset:8704
s_waitcnt vmcnt(4)
buffer_load_dwordx4 v[152:155], v2, s[20:23], s66 offen offset:256 nt
s_waitcnt lgkmcnt(8)
v_mfma_f32_16x16x32_bf16 v[16:19], v[176:179], a[0:3], 0
v_mfma_f32_16x16x32_bf16 v[16:19], v[180:183], a[4:7], v[16:19]
v_mfma_f32_16x16x32_bf16 v[16:19], v[184:187], a[8:11], v[16:19]
v_mfma_f32_16x16x32_bf16 v[16:19], v[188:191], a[12:15], v[16:19]
v_mfma_f32_16x16x32_bf16 v[16:19], v[192:195], a[16:19], v[16:19]
v_mfma_f32_16x16x32_bf16 v[16:19], v[196:199], a[20:23], v[16:19]
v_mfma_f32_16x16x32_bf16 v[16:19], v[200:203], a[24:27], v[16:19]
v_mfma_f32_16x16x32_bf16 v[16:19], v[204:207], a[28:31], v[16:19]
s_waitcnt vmcnt(4)
buffer_load_dwordx4 v[156:159], v2, s[20:23], s67 offen offset:256 nt
s_waitcnt lgkmcnt(0)
v_mfma_f32_16x16x32_bf16 v[20:23], v[208:211], a[0:3], 0
v_mfma_f32_16x16x32_bf16 v[20:23], v[212:215], a[4:7], v[20:23]
v_mfma_f32_16x16x32_bf16 v[20:23], v[216:219], a[8:11], v[20:23]
v_mfma_f32_16x16x32_bf16 v[20:23], v[220:223], a[12:15], v[20:23]
v_mfma_f32_16x16x32_bf16 v[20:23], v[224:227], a[16:19], v[20:23]
v_mfma_f32_16x16x32_bf16 v[20:23], v[228:231], a[20:23], v[20:23]
v_mfma_f32_16x16x32_bf16 v[20:23], v[232:235], a[24:27], v[20:23]
v_mfma_f32_16x16x32_bf16 v[20:23], v[236:239], a[28:31], v[20:23]
s_waitcnt vmcnt(4)
buffer_load_dwordx4 v[128:131], v2, s[20:23], s68 offen offset:0 nt
s_nop 7
v_max3_f32 v12, v16, v17, v18
v_max3_f32 v13, v19, v20, v21
v_max3_f32 v12, v12, v22, v23
v_max3_f32 v12, v12, v13, v8
v_mov_b32 v13, v12
s_nop 1
v_permlane16_swap_b32 v12, v13
v_max_f32 v12, v12, v13
v_mov_b32 v13, v12
s_nop 1
v_permlane32_swap_b32 v12, v13
v_max_f32 v12, v12, v13
v_sub_f32 v14, v8, v12
v_mul_f32 v15, s46, v12
v_mul_f32 v14, s46, v14
v_mov_b32 v8, v12
v_exp_f32 v10, v14
s_waitcnt vmcnt(4)
buffer_load_dwordx4 v[132:135], v2, s[20:23], s69 offen offset:0 nt
v_fma_f32 v16, v16, s46, -v15
v_fma_f32 v17, v17, s46, -v15
v_fma_f32 v18, v18, s46, -v15
v_fma_f32 v19, v19, s46, -v15
v_fma_f32 v20, v20, s46, -v15
v_fma_f32 v21, v21, s46, -v15
v_fma_f32 v22, v22, s46, -v15
v_fma_f32 v23, v23, s46, -v15
v_exp_f32 v16, v16
v_exp_f32 v17, v17
v_exp_f32 v18, v18
v_exp_f32 v19, v19
v_exp_f32 v20, v20
v_exp_f32 v21, v21
v_exp_f32 v22, v22
v_exp_f32 v23, v23
s_waitcnt vmcnt(4)
buffer_load_dwordx4 v[160:163], v2, s[20:23], s68 offen offset:256 nt
v_pk_mul_f32 v[48:49], v[48:49], v[10:11] op_sel_hi:[1,0]
v_pk_mul_f32 v[50:51], v[50:51], v[10:11] op_sel_hi:[1,0]
v_pk_mul_f32 v[52:53], v[52:53], v[10:11] op_sel_hi:[1,0]
v_pk_mul_f32 v[54:55], v[54:55], v[10:11] op_sel_hi:[1,0]
v_pk_mul_f32 v[56:57], v[56:57], v[10:11] op_sel_hi:[1,0]
v_pk_mul_f32 v[58:59], v[58:59], v[10:11] op_sel_hi:[1,0]
v_pk_mul_f32 v[60:61], v[60:61], v[10:11] op_sel_hi:[1,0]
v_pk_mul_f32 v[62:63], v[62:63], v[10:11] op_sel_hi:[1,0]
v_pk_mul_f32 v[64:65], v[64:65], v[10:11] op_sel_hi:[1,0]
v_pk_mul_f32 v[66:67], v[66:67], v[10:11] op_sel_hi:[1,0]
v_pk_mul_f32 v[68:69], v[68:69], v[10:11] op_sel_hi:[1,0]
v_pk_mul_f32 v[70:71], v[70:71], v[10:11] op_sel_hi:[1,0]
v_pk_mul_f32 v[72:73], v[72:73], v[10:11] op_sel_hi:[1,0]
v_pk_mul_f32 v[74:75], v[74:75], v[10:11] op_sel_hi:[1,0]
v_pk_mul_f32 v[76:77], v[76:77], v[10:11] op_sel_hi:[1,0]
v_pk_mul_f32 v[78:79], v[78:79], v[10:11] op_sel_hi:[1,0]
s_waitcnt vmcnt(4)
buffer_load_dwordx4 v[164:167], v2, s[20:23], s69 offen offset:256 nt
v_cvt_pk_bf16_f32 v24, v16, v17
v_cvt_pk_bf16_f32 v25, v18, v19
v_cvt_pk_bf16_f32 v26, v20, v21
v_cvt_pk_bf16_f32 v27, v22, v23
v_add_f32 v12, v16, v17
v_add_f32 v13, v18, v19
v_add_f32 v14, v20, v21
v_add_f32 v22, v22, v23
v_add_f32 v12, v12, v13
v_add_f32 v14, v14, v22
v_add_f32 v12, v12, v14
v_fma_f32 v9, v9, v10, v12
s_waitcnt vmcnt(4)
buffer_load_dwordx4 v[136:139], v2, s[20:23], s70 offen offset:0 nt
v_pk_mul_f32 v[80:81], v[80:81], v[10:11] op_sel_hi:[1,0]
v_pk_mul_f32 v[82:83], v[82:83], v[10:11] op_sel_hi:[1,0]
v_pk_mul_f32 v[84:85], v[84:85], v[10:11] op_sel_hi:[1,0]
v_pk_mul_f32 v[86:87], v[86:87], v[10:11] op_sel_hi:[1,0]
v_pk_mul_f32 v[88:89], v[88:89], v[10:11] op_sel_hi:[1,0]
v_pk_mul_f32 v[90:91], v[90:91], v[10:11] op_sel_hi:[1,0]
v_pk_mul_f32 v[92:93], v[92:93], v[10:11] op_sel_hi:[1,0]
v_pk_mul_f32 v[94:95], v[94:95], v[10:11] op_sel_hi:[1,0]
v_pk_mul_f32 v[96:97], v[96:97], v[10:11] op_sel_hi:[1,0]
v_pk_mul_f32 v[98:99], v[98:99], v[10:11] op_sel_hi:[1,0]
v_pk_mul_f32 v[100:101], v[100:101], v[10:11] op_sel_hi:[1,0]
v_pk_mul_f32 v[102:103], v[102:103], v[10:11] op_sel_hi:[1,0]
v_pk_mul_f32 v[104:105], v[104:105], v[10:11] op_sel_hi:[1,0]
v_pk_mul_f32 v[106:107], v[106:107], v[10:11] op_sel_hi:[1,0]
v_pk_mul_f32 v[108:109], v[108:109], v[10:11] op_sel_hi:[1,0]
v_pk_mul_f32 v[110:111], v[110:111], v[10:11] op_sel_hi:[1,0]
s_waitcnt vmcnt(4)
buffer_load_dwordx4 v[140:143], v2, s[20:23], s71 offen offset:0 nt
s_waitcnt vmcnt(4)
buffer_load_dwordx4 v[168:171], v2, s[20:23], s70 offen offset:256 nt
s_waitcnt vmcnt(4)
buffer_load_dwordx4 v[172:175], v2, s[20:23], s71 offen offset:256 nt
s_mov_b32 s64, s58
s_bitcmp1_b32 s43, 0
s_cselect_b32 s65, 0x96000, 0
s_xor_b32 s64, s64, s65
s_bitcmp1_b32 s43, 1
s_cselect_b32 s65, 0x38000, 0
s_xor_b32 s64, s64, s65
s_bitcmp1_b32 s43, 2
s_cselect_b32 s65, 0x96800, 0
s_xor_b32 s64, s64, s65
s_bitcmp1_b32 s43, 3
s_cselect_b32 s65, 0x94800, 0
s_xor_b32 s64, s64, s65
s_xor_b32 s65, s64, 0x2a0000
s_xor_b32 s66, s64, 0x212000
s_xor_b32 s67, s65, 0x212000
s_xor_b32 s68, s64, 0x202000
s_xor_b32 s69, s65, 0x202000
s_xor_b32 s70, s66, 0x202000
s_xor_b32 s71, s67, 0x202000
s_add_u32 s43, s43, 1
s_add_u32 m0, s59, 0
s_waitcnt vmcnt(4)
buffer_load_dwordx4 v1, s[16:19], s64 offen offset:0 nt lds
s_add_u32 s26, s26, 1
v_mov_b32 v242, s26
s_mov_b64 exec, 1
buffer_store_dword v242, off, s[32:35], s25
s_mov_b64 exec, 0xffffffff
buffer_load_dword v255, v248, s[32:35], 0 offen sc1
s_mov_b64 exec, -1
s_add_u32 m0, s59, 2112
s_waitcnt vmcnt(6)
buffer_load_dwordx4 v1, s[16:19], s65 offen offset:0 nt lds
s_add_u32 m0, s59, 32
s_waitcnt vmcnt(6)
buffer_load_dwordx4 v1, s[16:19], s64 offen offset:1024 nt lds
s_add_u32 m0, s59, 2144
s_waitcnt vmcnt(6)
buffer_load_dwordx4 v1, s[16:19], s65 offen offset:1024 nt lds
s_add_u32 m0, s59, 4224
s_waitcnt vmcnt(6)
buffer_load_dwordx4 v1, s[16:19], s66 offen offset:0 nt lds
v_perm_b32 v32, v116, v112, s47
v_perm_b32 v36, v116, v112, s48
v_perm_b32 v33, v124, v120, s47
v_perm_b32 v37, v124, v120, s48
v_perm_b32 v34, v132, v128, s47
v_perm_b32 v38, v132, v128, s48
v_perm_b32 v35, v140, v136, s47
v_perm_b32 v39, v140, v136, s48
v_perm_b32 v40, v117, v113, s47
v_perm_b32 v44, v117, v113, s48
v_perm_b32 v41, v125, v121, s47
v_perm_b32 v45, v125, v121, s48
v_perm_b32 v42, v133, v129, s47
v_perm_b32 v46, v133, v129, s48
v_perm_b32 v43, v141, v137, s47
v_perm_b32 v47, v141, v137, s48
v_mfma_f32_16x16x32_bf16 v[48:51], v[32:35], v[24:27], v[48:51]
v_mfma_f32_16x16x32_bf16 v[52:55], v[36:39], v[24:27], v[52:55]
s_add_u32 m0, s59, 6336
s_waitcnt vmcnt(6)
buffer_load_dwordx4 v1, s[16:19], s67 offen offset:0 nt lds
v_perm_b32 v32, v118, v114, s47
v_perm_b32 v36, v118, v114, s48
v_perm_b32 v33, v126, v122, s47
v_perm_b32 v37, v126, v122, s48
v_perm_b32 v34, v134, v130, s47
v_perm_b32 v38, v134, v130, s48
v_perm_b32 v35, v142, v138, s47
v_perm_b32 v39, v142, v138, s48
v_mfma_f32_16x16x32_bf16 v[56:59], v[40:43], v[24:27], v[56:59]
v_mfma_f32_16x16x32_bf16 v[60:63], v[44:47], v[24:27], v[60:63]
s_add_u32 m0, s59, 4256
s_waitcnt vmcnt(4)
buffer_load_dwordx4 v1, s[16:19], s66 offen offset:1024 nt lds
v_subrev_u32 v255, s26, v255
v_cmp_gt_u32 s[60:61], 32, v255
s_nop 0
s_and_b32 s50, s60, 0xffffffff
s_bcnt1_i32_b32 s50, s50
v_add_u32 v255, 32, v255
v_cmp_gt_u32 s[60:61], 32, v255
s_nop 0
s_and_b32 s49, s60, 0xffffffff
s_bcnt1_i32_b32 s49, s49
s_cmp_ge_u32 s49, s82
s_cselect_b32 s51, 1, 0
s_cmp_ge_i32 s50, s83
s_cselect_b32 s51, 2, s51
v_mov_b32 v242, s51
s_mov_b64 exec, 1
ds_write_b32 v250, v242 offset:8
s_mov_b64 exec, -1
ds_read_b32 v30, v251 offset:8
v_perm_b32 v40, v119, v115, s47
v_perm_b32 v44, v119, v115, s48
v_perm_b32 v41, v127, v123, s47
v_perm_b32 v45, v127, v123, s48
v_perm_b32 v42, v135, v131, s47
v_perm_b32 v46, v135, v131, s48
v_perm_b32 v43, v143, v139, s47
v_perm_b32 v47, v143, v139, s48
v_mfma_f32_16x16x32_bf16 v[64:67], v[32:35], v[24:27], v[64:67]
v_mfma_f32_16x16x32_bf16 v[68:71], v[36:39], v[24:27], v[68:71]
s_add_u32 m0, s59, 6368
s_waitcnt vmcnt(4)
buffer_load_dwordx4 v1, s[16:19], s67 offen offset:1024 nt lds
s_waitcnt lgkmcnt(0)
v_readfirstlane_b32 s24, v30
s_nop 0
s_bitcmp1_b32 s24, 1
s_cselect_b64 vcc, -1, 0
v_perm_b32 v32, v148, v144, s47
v_perm_b32 v36, v148, v144, s48
v_perm_b32 v33, v156, v152, s47
v_perm_b32 v37, v156, v152, s48
v_perm_b32 v34, v164, v160, s47
v_perm_b32 v38, v164, v160, s48
v_perm_b32 v35, v172, v168, s47
v_perm_b32 v39, v172, v168, s48
v_mfma_f32_16x16x32_bf16 v[72:75], v[40:43], v[24:27], v[72:75]
v_mfma_f32_16x16x32_bf16 v[76:79], v[44:47], v[24:27], v[76:79]
s_add_u32 m0, s59, 8448
s_cbranch_vccnz L_w1
s_waitcnt vmcnt(4)
s_bitcmp1_b32 s24, 0
s_cbranch_scc0 L_w1
s_waitcnt vmcnt(3)
L_w1:
buffer_load_dwordx4 v1, s[16:19], s68 offen offset:0 nt lds
v_perm_b32 v40, v149, v145, s47
v_perm_b32 v44, v149, v145, s48
v_perm_b32 v41, v157, v153, s47
v_perm_b32 v45, v157, v153, s48
v_perm_b32 v42, v165, v161, s47
v_perm_b32 v46, v165, v161, s48
v_perm_b32 v43, v173, v169, s47
v_perm_b32 v47, v173, v169, s48
v_mfma_f32_16x16x32_bf16 v[80:83], v[32:35], v[24:27], v[80:83]
v_mfma_f32_16x16x32_bf16 v[84:87], v[36:39], v[24:27], v[84:87]
s_add_u32 m0, s59, 10560
s_waitcnt vmcnt(5)
s_cbranch_vccnz L_w2
s_waitcnt vmcnt(4)
s_bitcmp1_b32 s24, 0
s_cbranch_scc0 L_w2
s_waitcnt vmcnt(3)
L_w2:
buffer_load_dwordx4 v1, s[16:19], s69 offen offset:0 nt lds
v_perm_b32 v32, v150, v146, s47
v_perm_b32 v36, v150, v146, s48
v_perm_b32 v33, v158, v154, s47
v_perm_b32 v37, v158, v154, s48
v_perm_b32 v34, v166, v162, s47
v_perm_b32 v38, v166, v162, s48
v_perm_b32 v35, v174, v170, s47
v_perm_b32 v39, v174, v170, s48
v_mfma_f32_16x16x32_bf16 v[88:91], v[40:43], v[24:27], v[88:91]
v_mfma_f32_16x16x32_bf16 v[92:95], v[44:47], v[24:27], v[92:95]
s_add_u32 m0, s59, 8480
s_waitcnt vmcnt(5)
s_cbranch_vccnz L_w3
s_waitcnt vmcnt(4)
s_bitcmp1_b32 s24, 0
s_cbranch_scc0 L_w3
s_waitcnt vmcnt(3)
L_w3:
buffer_load_dwordx4 v1, s[16:19], s68 offen offset:1024 nt lds
v_perm_b32 v40, v151, v147, s47
v_perm_b32 v44, v151, v147, s48
v_perm_b32 v41, v159, v155, s47
v_perm_b32 v45, v159, v155, s48
v_perm_b32 v42, v167, v163, s47
v_perm_b32 v46, v167, v163, s48
v_perm_b32 v43, v175, v171, s47
v_perm_b32 v47, v175, v171, s48
v_mfma_f32_16x16x32_bf16 v[96:99], v[32:35], v[24:27], v[96:99]
v_mfma_f32_16x16x32_bf16 v[100:103], v[36:39], v[24:27], v[100:103]
s_add_u32 m0, s59, 10592
s_waitcnt vmcnt(5)
s_cbranch_vccnz L_w4
s_waitcnt vmcnt(4)
s_bitcmp1_b32 s24, 0
s_cbranch_scc0 L_w4
s_waitcnt vmcnt(3)
L_w4:
buffer_load_dwordx4 v1, s[16:19], s69 offen offset:1024 nt lds
v_mfma_f32_16x16x32_bf16 v[104:107], v[40:43], v[24:27], v[104:107]
v_mfma_f32_16x16x32_bf16 v[108:111], v[44:47], v[24:27], v[108:111]
s_add_u32 m0, s59, 12672
s_waitcnt vmcnt(5)
s_cbranch_vccnz L_w5
s_waitcnt vmcnt(4)
s_bitcmp1_b32 s24, 0
s_cbranch_scc0 L_w5
s_waitcnt vmcnt(3)
L_w5:
buffer_load_dwordx4 v1, s[16:19], s70 offen offset:0 nt lds
s_add_u32 m0, s59, 14784
s_waitcnt vmcnt(5)
s_cbranch_vccnz L_w6
s_waitcnt vmcnt(4)
s_bitcmp1_b32 s24, 0
s_cbranch_scc0 L_w6
s_waitcnt vmcnt(3)
L_w6:
buffer_load_dwordx4 v1, s[16:19], s71 offen offset:0 nt lds
s_add_u32 m0, s59, 12704
s_waitcnt vmcnt(5)
s_cbranch_vccnz L_w7
s_waitcnt vmcnt(4)
s_bitcmp1_b32 s24, 0
s_cbranch_scc0 L_w7
s_waitcnt vmcnt(3)
L_w7:
buffer_load_dwordx4 v1, s[16:19], s70 offen offset:1024 nt lds
s_add_u32 m0, s59, 14816
s_waitcnt vmcnt(5)
s_cbranch_vccnz L_w8
s_waitcnt vmcnt(4)
s_bitcmp1_b32 s24, 0
s_cbranch_scc0 L_w8
s_waitcnt vmcnt(3)
L_w8:
buffer_load_dwordx4 v1, s[16:19], s71 offen offset:1024 nt lds
s_mov_b32 s45, 13
.p2align 6
L_loop:
s_waitcnt vmcnt(4)
buffer_load_dwordx4 v[112:115], v2, s[20:23], s64 offen offset:0 nt
s_waitcnt vmcnt(4)
buffer_load_dwordx4 v[116:119], v2, s[20:23], s65 offen offset:0 nt
s_waitcnt vmcnt(4)
buffer_load_dwordx4 v[144:147], v2, s[20:23], s64 offen offset:256 nt
s_waitcnt vmcnt(4)
buffer_load_dwordx4 v[148:151], v2, s[20:23], s65 offen offset:256 nt
s_waitcnt vmcnt(4)
buffer_load_dwordx4 v[120:123], v2, s[20:23], s66 offen offset:0 nt
ds_read_b128 v[176:179], v4 offset:0
ds_read_b128 v[180:183], v5 offset:0
ds_read_b128 v[184:187], v6 offset:0
ds_read_b128 v[188:191], v7 offset:0
ds_read_b128 v[192:195], v4 offset:256
ds_read_b128 v[196:199], v5 offset:256
ds_read_b128 v[200:203], v6 offset:256
ds_read_b128 v[204:207], v7 offset:256
s_waitcnt vmcnt(4)
buffer_load_dwordx4 v[124:127], v2, s[20:23], s67 offen offset:0 nt
ds_read_b128 v[208:211], v4 offset:8448
ds_read_b128 v[212:215], v5 offset:8448
ds_read_b128 v[216:219], v6 offset:8448
ds_read_b128 v[220:223], v7 offset:8448
ds_read_b128 v[224:227], v4 offset:8704
ds_read_b128 v[228:231], v5 offset:8704
ds_read_b128 v[232:235], v6 offset:8704
ds_read_b128 v[236:239], v7 offset:8704
s_waitcnt vmcnt(4)
buffer_load_dwordx4 v[152:155], v2, s[20:23], s66 offen offset:256 nt
s_waitcnt lgkmcnt(8)
v_mfma_f32_16x16x32_bf16 v[16:19], v[176:179], a[0:3], 0
v_mfma_f32_16x16x32_bf16 v[16:19], v[180:183], a[4:7], v[16:19]
v_mfma_f32_16x16x32_bf16 v[16:19], v[184:187], a[8:11], v[16:19]
v_mfma_f32_16x16x32_bf16 v[16:19], v[188:191], a[12:15], v[16:19]
v_mfma_f32_16x16x32_bf16 v[16:19], v[192:195], a[16:19], v[16:19]
v_mfma_f32_16x16x32_bf16 v[16:19], v[196:199], a[20:23], v[16:19]
v_mfma_f32_16x16x32_bf16 v[16:19], v[200:203], a[24:27], v[16:19]
v_mfma_f32_16x16x32_bf16 v[16:19], v[204:207], a[28:31], v[16:19]
s_waitcnt vmcnt(4)
buffer_load_dwordx4 v[156:159], v2, s[20:23], s67 offen offset:256 nt
s_waitcnt lgkmcnt(0)
v_mfma_f32_16x16x32_bf16 v[20:23], v[208:211], a[0:3], 0
v_mfma_f32_16x16x32_bf16 v[20:23], v[212:215], a[4:7], v[20:23]
v_mfma_f32_16x16x32_bf16 v[20:23], v[216:219], a[8:11], v[20:23]
v_mfma_f32_16x16x32_bf16 v[20:23], v[220:223], a[12:15], v[20:23]
v_mfma_f32_16x16x32_bf16 v[20:23], v[224:227], a[16:19], v[20:23]
v_mfma_f32_16x16x32_bf16 v[20:23], v[228:231], a[20:23], v[20:23]
v_mfma_f32_16x16x32_bf16 v[20:23], v[232:235], a[24:27], v[20:23]
v_mfma_f32_16x16x32_bf16 v[20:23], v[236:239], a[28:31], v[20:23]
s_waitcnt vmcnt(4)
buffer_load_dwordx4 v[128:131], v2, s[20:23], s68 offen offset:0 nt
s_nop 7
v_max3_f32 v12, v16, v17, v18
v_max3_f32 v13, v19, v20, v21
v_max3_f32 v12, v12, v22, v23
v_max3_f32 v12, v12, v13, v8
v_mov_b32 v13, v12
s_nop 1
v_permlane16_swap_b32 v12, v13
v_max_f32 v12, v12, v13
v_mov_b32 v13, v12
s_nop 1
v_permlane32_swap_b32 v12, v13
v_max_f32 v12, v12, v13
v_sub_f32 v14, v8, v12
v_mul_f32 v15, s46, v12
v_mul_f32 v14, s46, v14
v_mov_b32 v8, v12
v_exp_f32 v10, v14
s_waitcnt vmcnt(4)
buffer_load_dwordx4 v[132:135], v2, s[20:23], s69 offen offset:0 nt
v_fma_f32 v16, v16, s46, -v15
v_fma_f32 v17, v17, s46, -v15
v_fma_f32 v18, v18, s46, -v15
v_fma_f32 v19, v19, s46, -v15
v_fma_f32 v20, v20, s46, -v15
v_fma_f32 v21, v21, s46, -v15
v_fma_f32 v22, v22, s46, -v15
v_fma_f32 v23, v23, s46, -v15
v_exp_f32 v16, v16
v_exp_f32 v17, v17
v_exp_f32 v18, v18
v_exp_f32 v19, v19
v_exp_f32 v20, v20
v_exp_f32 v21, v21
v_exp_f32 v22, v22
v_exp_f32 v23, v23
s_waitcnt vmcnt(4)
buffer_load_dwordx4 v[160:163], v2, s[20:23], s68 offen offset:256 nt
v_pk_mul_f32 v[48:49], v[48:49], v[10:11] op_sel_hi:[1,0]
v_pk_mul_f32 v[50:51], v[50:51], v[10:11] op_sel_hi:[1,0]
v_pk_mul_f32 v[52:53], v[52:53], v[10:11] op_sel_hi:[1,0]
v_pk_mul_f32 v[54:55], v[54:55], v[10:11] op_sel_hi:[1,0]
v_pk_mul_f32 v[56:57], v[56:57], v[10:11] op_sel_hi:[1,0]
v_pk_mul_f32 v[58:59], v[58:59], v[10:11] op_sel_hi:[1,0]
v_pk_mul_f32 v[60:61], v[60:61], v[10:11] op_sel_hi:[1,0]
v_pk_mul_f32 v[62:63], v[62:63], v[10:11] op_sel_hi:[1,0]
v_pk_mul_f32 v[64:65], v[64:65], v[10:11] op_sel_hi:[1,0]
v_pk_mul_f32 v[66:67], v[66:67], v[10:11] op_sel_hi:[1,0]
v_pk_mul_f32 v[68:69], v[68:69], v[10:11] op_sel_hi:[1,0]
v_pk_mul_f32 v[70:71], v[70:71], v[10:11] op_sel_hi:[1,0]
v_pk_mul_f32 v[72:73], v[72:73], v[10:11] op_sel_hi:[1,0]
v_pk_mul_f32 v[74:75], v[74:75], v[10:11] op_sel_hi:[1,0]
v_pk_mul_f32 v[76:77], v[76:77], v[10:11] op_sel_hi:[1,0]
v_pk_mul_f32 v[78:79], v[78:79], v[10:11] op_sel_hi:[1,0]
s_waitcnt vmcnt(4)
buffer_load_dwordx4 v[164:167], v2, s[20:23], s69 offen offset:256 nt
v_cvt_pk_bf16_f32 v24, v16, v17
v_cvt_pk_bf16_f32 v25, v18, v19
v_cvt_pk_bf16_f32 v26, v20, v21
v_cvt_pk_bf16_f32 v27, v22, v23
v_add_f32 v12, v16, v17
v_add_f32 v13, v18, v19
v_add_f32 v14, v20, v21
v_add_f32 v22, v22, v23
v_add_f32 v12, v12, v13
v_add_f32 v14, v14, v22
v_add_f32 v12, v12, v14
v_fma_f32 v9, v9, v10, v12
s_waitcnt vmcnt(4)
buffer_load_dwordx4 v[136:139], v2, s[20:23], s70 offen offset:0 nt
v_pk_mul_f32 v[80:81], v[80:81], v[10:11] op_sel_hi:[1,0]
v_pk_mul_f32 v[82:83], v[82:83], v[10:11] op_sel_hi:[1,0]
v_pk_mul_f32 v[84:85], v[84:85], v[10:11] op_sel_hi:[1,0]
v_pk_mul_f32 v[86:87], v[86:87], v[10:11] op_sel_hi:[1,0]
v_pk_mul_f32 v[88:89], v[88:89], v[10:11] op_sel_hi:[1,0]
v_pk_mul_f32 v[90:91], v[90:91], v[10:11] op_sel_hi:[1,0]
v_pk_mul_f32 v[92:93], v[92:93], v[10:11] op_sel_hi:[1,0]
v_pk_mul_f32 v[94:95], v[94:95], v[10:11] op_sel_hi:[1,0]
v_pk_mul_f32 v[96:97], v[96:97], v[10:11] op_sel_hi:[1,0]
v_pk_mul_f32 v[98:99], v[98:99], v[10:11] op_sel_hi:[1,0]
v_pk_mul_f32 v[100:101], v[100:101], v[10:11] op_sel_hi:[1,0]
v_pk_mul_f32 v[102:103], v[102:103], v[10:11] op_sel_hi:[1,0]
v_pk_mul_f32 v[104:105], v[104:105], v[10:11] op_sel_hi:[1,0]
v_pk_mul_f32 v[106:107], v[106:107], v[10:11] op_sel_hi:[1,0]
v_pk_mul_f32 v[108:109], v[108:109], v[10:11] op_sel_hi:[1,0]
v_pk_mul_f32 v[110:111], v[110:111], v[10:11] op_sel_hi:[1,0]
s_waitcnt vmcnt(4)
buffer_load_dwordx4 v[140:143], v2, s[20:23], s71 offen offset:0 nt
s_waitcnt vmcnt(4)
buffer_load_dwordx4 v[168:171], v2, s[20:23], s70 offen offset:256 nt
s_waitcnt vmcnt(4)
buffer_load_dwordx4 v[172:175], v2, s[20:23], s71 offen offset:256 nt
s_mov_b32 s64, s58
s_bitcmp1_b32 s43, 0
s_cselect_b32 s65, 0x96000, 0
s_xor_b32 s64, s64, s65
s_bitcmp1_b32 s43, 1
s_cselect_b32 s65, 0x38000, 0
s_xor_b32 s64, s64, s65
s_bitcmp1_b32 s43, 2
s_cselect_b32 s65, 0x96800, 0
s_xor_b32 s64, s64, s65
s_bitcmp1_b32 s43, 3
s_cselect_b32 s65, 0x94800, 0
s_xor_b32 s64, s64, s65
s_xor_b32 s65, s64, 0x2a0000
s_xor_b32 s66, s64, 0x212000
s_xor_b32 s67, s65, 0x212000
s_xor_b32 s68, s64, 0x202000
s_xor_b32 s69, s65, 0x202000
s_xor_b32 s70, s66, 0x202000
s_xor_b32 s71, s67, 0x202000
s_add_u32 s43, s43, 1
s_add_u32 m0, s59, 0
s_waitcnt vmcnt(4)
buffer_load_dwordx4 v1, s[16:19], s64 offen offset:0 nt lds
s_add_u32 s26, s26, 1
v_mov_b32 v242, s26
s_mov_b64 exec, 1
buffer_store_dword v242, off, s[32:35], s25
s_mov_b64 exec, 0xffffffff
buffer_load_dword v255, v248, s[32:35], 0 offen sc1
s_mov_b64 exec, -1
s_add_u32 m0, s59, 2112
s_waitcnt vmcnt(6)
buffer_load_dwordx4 v1, s[16:19], s65 offen offset:0 nt lds
s_add_u32 m0, s59, 32
s_waitcnt vmcnt(6)
buffer_load_dwordx4 v1, s[16:19], s64 offen offset:1024 nt lds
s_add_u32 m0, s59, 2144
s_waitcnt vmcnt(6)
buffer_load_dwordx4 v1, s[16:19], s65 offen offset:1024 nt lds
s_add_u32 m0, s59, 4224
s_waitcnt vmcnt(6)
buffer_load_dwordx4 v1, s[16:19], s66 offen offset:0 nt lds
v_perm_b32 v32, v116, v112, s47
v_perm_b32 v36, v116, v112, s48
v_perm_b32 v33, v124, v120, s47
v_perm_b32 v37, v124, v120, s48
v_perm_b32 v34, v132, v128, s47
v_perm_b32 v38, v132, v128, s48
v_perm_b32 v35, v140, v136, s47
v_perm_b32 v39, v140, v136, s48
v_perm_b32 v40, v117, v113, s47
v_perm_b32 v44, v117, v113, s48
v_perm_b32 v41, v125, v121, s47
v_perm_b32 v45, v125, v121, s48
v_perm_b32 v42, v133, v129, s47
v_perm_b32 v46, v133, v129, s48
v_perm_b32 v43, v141, v137, s47
v_perm_b32 v47, v141, v137, s48
v_mfma_f32_16x16x32_bf16 v[48:51], v[32:35], v[24:27], v[48:51]
v_mfma_f32_16x16x32_bf16 v[52:55], v[36:39], v[24:27], v[52:55]
s_add_u32 m0, s59, 6336
s_waitcnt vmcnt(6)
buffer_load_dwordx4 v1, s[16:19], s67 offen offset:0 nt lds
v_perm_b32 v32, v118, v114, s47
v_perm_b32 v36, v118, v114, s48
v_perm_b32 v33, v126, v122, s47
v_perm_b32 v37, v126, v122, s48
v_perm_b32 v34, v134, v130, s47
v_perm_b32 v38, v134, v130, s48
v_perm_b32 v35, v142, v138, s47
v_perm_b32 v39, v142, v138, s48
v_mfma_f32_16x16x32_bf16 v[56:59], v[40:43], v[24:27], v[56:59]
v_mfma_f32_16x16x32_bf16 v[60:63], v[44:47], v[24:27], v[60:63]
s_add_u32 m0, s59, 4256
s_waitcnt vmcnt(4)
buffer_load_dwordx4 v1, s[16:19], s66 offen offset:1024 nt lds
v_subrev_u32 v255, s26, v255
v_cmp_gt_u32 s[60:61], 32, v255
s_nop 0
s_and_b32 s50, s60, 0xffffffff
s_bcnt1_i32_b32 s50, s50
v_add_u32 v255, 32, v255
v_cmp_gt_u32 s[60:61], 32, v255
s_nop 0
s_and_b32 s49, s60, 0xffffffff
s_bcnt1_i32_b32 s49, s49
s_cmp_ge_u32 s49, s82
s_cselect_b32 s51, 1, 0
s_cmp_ge_i32 s50, s83
s_cselect_b32 s51, 2, s51
v_mov_b32 v242, s51
s_mov_b64 exec, 1
ds_write_b32 v250, v242 offset:8
s_mov_b64 exec, -1
ds_read_b32 v30, v251 offset:8
v_perm_b32 v40, v119, v115, s47
v_perm_b32 v44, v119, v115, s48
v_perm_b32 v41, v127, v123, s47
v_perm_b32 v45, v127, v123, s48
v_perm_b32 v42, v135, v131, s47
v_perm_b32 v46, v135, v131, s48
v_perm_b32 v43, v143, v139, s47
v_perm_b32 v47, v143, v139, s48
v_mfma_f32_16x16x32_bf16 v[64:67], v[32:35], v[24:27], v[64:67]
v_mfma_f32_16x16x32_bf16 v[68:71], v[36:39], v[24:27], v[68:71]
s_add_u32 m0, s59, 6368
s_waitcnt vmcnt(4)
buffer_load_dwordx4 v1, s[16:19], s67 offen offset:1024 nt lds
s_waitcnt lgkmcnt(0)
v_readfirstlane_b32 s24, v30
s_nop 0
s_bitcmp1_b32 s24, 1
s_cselect_b64 vcc, -1, 0
v_perm_b32 v32, v148, v144, s47
v_perm_b32 v36, v148, v144, s48
v_perm_b32 v33, v156, v152, s47
v_perm_b32 v37, v156, v152, s48
v_perm_b32 v34, v164, v160, s47
v_perm_b32 v38, v164, v160, s48
v_perm_b32 v35, v172, v168, s47
v_perm_b32 v39, v172, v168, s48
v_mfma_f32_16x16x32_bf16 v[72:75], v[40:43], v[24:27], v[72:75]
v_mfma_f32_16x16x32_bf16 v[76:79], v[44:47], v[24:27], v[76:79]
s_add_u32 m0, s59, 8448
s_cbranch_vccnz L_w9
s_waitcnt vmcnt(4)
s_bitcmp1_b32 s24, 0
s_cbranch_scc0 L_w9
s_waitcnt vmcnt(3)
L_w9:
buffer_load_dwordx4 v1, s[16:19], s68 offen offset:0 nt lds
v_perm_b32 v40, v149, v145, s47
v_perm_b32 v44, v149, v145, s48
v_perm_b32 v41, v157, v153, s47
v_perm_b32 v45, v157, v153, s48
v_perm_b32 v42, v165, v161, s47
v_perm_b32 v46, v165, v161, s48
v_perm_b32 v43, v173, v169, s47
v_perm_b32 v47, v173, v169, s48
v_mfma_f32_16x16x32_bf16 v[80:83], v[32:35], v[24:27], v[80:83]
v_mfma_f32_16x16x32_bf16 v[84:87], v[36:39], v[24:27], v[84:87]
s_add_u32 m0, s59, 10560
s_waitcnt vmcnt(5)
s_cbranch_vccnz L_w10
s_waitcnt vmcnt(4)
s_bitcmp1_b32 s24, 0
s_cbranch_scc0 L_w10
s_waitcnt vmcnt(3)
L_w10:
buffer_load_dwordx4 v1, s[16:19], s69 offen offset:0 nt lds
v_perm_b32 v32, v150, v146, s47
v_perm_b32 v36, v150, v146, s48
v_perm_b32 v33, v158, v154, s47
v_perm_b32 v37, v158, v154, s48
v_perm_b32 v34, v166, v162, s47
v_perm_b32 v38, v166, v162, s48
v_perm_b32 v35, v174, v170, s47
v_perm_b32 v39, v174, v170, s48
v_mfma_f32_16x16x32_bf16 v[88:91], v[40:43], v[24:27], v[88:91]
v_mfma_f32_16x16x32_bf16 v[92:95], v[44:47], v[24:27], v[92:95]
s_add_u32 m0, s59, 8480
s_waitcnt vmcnt(5)
s_cbranch_vccnz L_w11
s_waitcnt vmcnt(4)
s_bitcmp1_b32 s24, 0
s_cbranch_scc0 L_w11
s_waitcnt vmcnt(3)
L_w11:
buffer_load_dwordx4 v1, s[16:19], s68 offen offset:1024 nt lds
v_perm_b32 v40, v151, v147, s47
v_perm_b32 v44, v151, v147, s48
v_perm_b32 v41, v159, v155, s47
v_perm_b32 v45, v159, v155, s48
v_perm_b32 v42, v167, v163, s47
v_perm_b32 v46, v167, v163, s48
v_perm_b32 v43, v175, v171, s47
v_perm_b32 v47, v175, v171, s48
v_mfma_f32_16x16x32_bf16 v[96:99], v[32:35], v[24:27], v[96:99]
v_mfma_f32_16x16x32_bf16 v[100:103], v[36:39], v[24:27], v[100:103]
s_add_u32 m0, s59, 10592
s_waitcnt vmcnt(5)
s_cbranch_vccnz L_w12
s_waitcnt vmcnt(4)
s_bitcmp1_b32 s24, 0
s_cbranch_scc0 L_w12
s_waitcnt vmcnt(3)
L_w12:
buffer_load_dwordx4 v1, s[16:19], s69 offen offset:1024 nt lds
v_mfma_f32_16x16x32_bf16 v[104:107], v[40:43], v[24:27], v[104:107]
v_mfma_f32_16x16x32_bf16 v[108:111], v[44:47], v[24:27], v[108:111]
s_add_u32 m0, s59, 12672
s_waitcnt vmcnt(5)
s_cbranch_vccnz L_w13
s_waitcnt vmcnt(4)
s_bitcmp1_b32 s24, 0
s_cbranch_scc0 L_w13
s_waitcnt vmcnt(3)
L_w13:
buffer_load_dwordx4 v1, s[16:19], s70 offen offset:0 nt lds
s_add_u32 m0, s59, 14784
s_waitcnt vmcnt(5)
s_cbranch_vccnz L_w14
s_waitcnt vmcnt(4)
s_bitcmp1_b32 s24, 0
s_cbranch_scc0 L_w14
s_waitcnt vmcnt(3)
L_w14:
buffer_load_dwordx4 v1, s[16:19], s71 offen offset:0 nt lds
s_add_u32 m0, s59, 12704
s_waitcnt vmcnt(5)
s_cbranch_vccnz L_w15
s_waitcnt vmcnt(4)
s_bitcmp1_b32 s24, 0
s_cbranch_scc0 L_w15
s_waitcnt vmcnt(3)
L_w15:
buffer_load_dwordx4 v1, s[16:19], s70 offen offset:1024 nt lds
s_add_u32 m0, s59, 14816
s_waitcnt vmcnt(5)
s_cbranch_vccnz L_w16
s_waitcnt vmcnt(4)
s_bitcmp1_b32 s24, 0
s_cbranch_scc0 L_w16
s_waitcnt vmcnt(3)
L_w16:
buffer_load_dwordx4 v1, s[16:19], s71 offen offset:1024 nt lds
s_sub_u32 s45, s45, 1
s_cmp_lg_u32 s45, 0
s_cbranch_scc1 L_loop
s_waitcnt vmcnt(4)
buffer_load_dwordx4 v[112:115], v2, s[20:23], s64 offen offset:0 nt
s_waitcnt vmcnt(4)
buffer_load_dwordx4 v[116:119], v2, s[20:23], s65 offen offset:0 nt
s_waitcnt vmcnt(4)
buffer_load_dwordx4 v[144:147], v2, s[20:23], s64 offen offset:256 nt
s_waitcnt vmcnt(4)
buffer_load_dwordx4 v[148:151], v2, s[20:23], s65 offen offset:256 nt
s_waitcnt vmcnt(4)
buffer_load_dwordx4 v[120:123], v2, s[20:23], s66 offen offset:0 nt
ds_read_b128 v[176:179], v4 offset:0
ds_read_b128 v[180:183], v5 offset:0
ds_read_b128 v[184:187], v6 offset:0
ds_read_b128 v[188:191], v7 offset:0
ds_read_b128 v[192:195], v4 offset:256
ds_read_b128 v[196:199], v5 offset:256
ds_read_b128 v[200:203], v6 offset:256
ds_read_b128 v[204:207], v7 offset:256
s_waitcnt vmcnt(4)
buffer_load_dwordx4 v[124:127], v2, s[20:23], s67 offen offset:0 nt
ds_read_b128 v[208:211], v4 offset:8448
ds_read_b128 v[212:215], v5 offset:8448
ds_read_b128 v[216:219], v6 offset:8448
ds_read_b128 v[220:223], v7 offset:8448
ds_read_b128 v[224:227], v4 offset:8704
ds_read_b128 v[228:231], v5 offset:8704
ds_read_b128 v[232:235], v6 offset:8704
ds_read_b128 v[236:239], v7 offset:8704
s_waitcnt vmcnt(4)
buffer_load_dwordx4 v[152:155], v2, s[20:23], s66 offen offset:256 nt
s_waitcnt lgkmcnt(8)
v_mfma_f32_16x16x32_bf16 v[16:19], v[176:179], a[0:3], 0
v_mfma_f32_16x16x32_bf16 v[16:19], v[180:183], a[4:7], v[16:19]
v_mfma_f32_16x16x32_bf16 v[16:19], v[184:187], a[8:11], v[16:19]
v_mfma_f32_16x16x32_bf16 v[16:19], v[188:191], a[12:15], v[16:19]
v_mfma_f32_16x16x32_bf16 v[16:19], v[192:195], a[16:19], v[16:19]
v_mfma_f32_16x16x32_bf16 v[16:19], v[196:199], a[20:23], v[16:19]
v_mfma_f32_16x16x32_bf16 v[16:19], v[200:203], a[24:27], v[16:19]
v_mfma_f32_16x16x32_bf16 v[16:19], v[204:207], a[28:31], v[16:19]
s_waitcnt vmcnt(4)
buffer_load_dwordx4 v[156:159], v2, s[20:23], s67 offen offset:256 nt
s_waitcnt lgkmcnt(0)
v_mfma_f32_16x16x32_bf16 v[20:23], v[208:211], a[0:3], 0
v_mfma_f32_16x16x32_bf16 v[20:23], v[212:215], a[4:7], v[20:23]
v_mfma_f32_16x16x32_bf16 v[20:23], v[216:219], a[8:11], v[20:23]
v_mfma_f32_16x16x32_bf16 v[20:23], v[220:223], a[12:15], v[20:23]
v_mfma_f32_16x16x32_bf16 v[20:23], v[224:227], a[16:19], v[20:23]
v_mfma_f32_16x16x32_bf16 v[20:23], v[228:231], a[20:23], v[20:23]
v_mfma_f32_16x16x32_bf16 v[20:23], v[232:235], a[24:27], v[20:23]
v_mfma_f32_16x16x32_bf16 v[20:23], v[236:239], a[28:31], v[20:23]
s_waitcnt vmcnt(4)
buffer_load_dwordx4 v[128:131], v2, s[20:23], s68 offen offset:0 nt
s_nop 7
v_max3_f32 v12, v16, v17, v18
v_max3_f32 v13, v19, v20, v21
v_max3_f32 v12, v12, v22, v23
v_max3_f32 v12, v12, v13, v8
v_mov_b32 v13, v12
s_nop 1
v_permlane16_swap_b32 v12, v13
v_max_f32 v12, v12, v13
v_mov_b32 v13, v12
s_nop 1
v_permlane32_swap_b32 v12, v13
v_max_f32 v12, v12, v13
v_sub_f32 v14, v8, v12
v_mul_f32 v15, s46, v12
v_mul_f32 v14, s46, v14
v_mov_b32 v8, v12
v_exp_f32 v10, v14
s_waitcnt vmcnt(4)
buffer_load_dwordx4 v[132:135], v2, s[20:23], s69 offen offset:0 nt
v_fma_f32 v16, v16, s46, -v15
v_fma_f32 v17, v17, s46, -v15
v_fma_f32 v18, v18, s46, -v15
v_fma_f32 v19, v19, s46, -v15
v_fma_f32 v20, v20, s46, -v15
v_fma_f32 v21, v21, s46, -v15
v_fma_f32 v22, v22, s46, -v15
v_fma_f32 v23, v23, s46, -v15
v_exp_f32 v16, v16
v_exp_f32 v17, v17
v_exp_f32 v18, v18
v_exp_f32 v19, v19
v_exp_f32 v20, v20
v_exp_f32 v21, v21
v_exp_f32 v22, v22
v_exp_f32 v23, v23
s_waitcnt vmcnt(4)
buffer_load_dwordx4 v[160:163], v2, s[20:23], s68 offen offset:256 nt
v_pk_mul_f32 v[48:49], v[48:49], v[10:11] op_sel_hi:[1,0]
v_pk_mul_f32 v[50:51], v[50:51], v[10:11] op_sel_hi:[1,0]
v_pk_mul_f32 v[52:53], v[52:53], v[10:11] op_sel_hi:[1,0]
v_pk_mul_f32 v[54:55], v[54:55], v[10:11] op_sel_hi:[1,0]
v_pk_mul_f32 v[56:57], v[56:57], v[10:11] op_sel_hi:[1,0]
v_pk_mul_f32 v[58:59], v[58:59], v[10:11] op_sel_hi:[1,0]
v_pk_mul_f32 v[60:61], v[60:61], v[10:11] op_sel_hi:[1,0]
v_pk_mul_f32 v[62:63], v[62:63], v[10:11] op_sel_hi:[1,0]
v_pk_mul_f32 v[64:65], v[64:65], v[10:11] op_sel_hi:[1,0]
v_pk_mul_f32 v[66:67], v[66:67], v[10:11] op_sel_hi:[1,0]
v_pk_mul_f32 v[68:69], v[68:69], v[10:11] op_sel_hi:[1,0]
v_pk_mul_f32 v[70:71], v[70:71], v[10:11] op_sel_hi:[1,0]
v_pk_mul_f32 v[72:73], v[72:73], v[10:11] op_sel_hi:[1,0]
v_pk_mul_f32 v[74:75], v[74:75], v[10:11] op_sel_hi:[1,0]
v_pk_mul_f32 v[76:77], v[76:77], v[10:11] op_sel_hi:[1,0]
v_pk_mul_f32 v[78:79], v[78:79], v[10:11] op_sel_hi:[1,0]
s_waitcnt vmcnt(4)
buffer_load_dwordx4 v[164:167], v2, s[20:23], s69 offen offset:256 nt
v_cvt_pk_bf16_f32 v24, v16, v17
v_cvt_pk_bf16_f32 v25, v18, v19
v_cvt_pk_bf16_f32 v26, v20, v21
v_cvt_pk_bf16_f32 v27, v22, v23
v_add_f32 v12, v16, v17
v_add_f32 v13, v18, v19
v_add_f32 v14, v20, v21
v_add_f32 v22, v22, v23
v_add_f32 v12, v12, v13
v_add_f32 v14, v14, v22
v_add_f32 v12, v12, v14
v_fma_f32 v9, v9, v10, v12
s_waitcnt vmcnt(4)
buffer_load_dwordx4 v[136:139], v2, s[20:23], s70 offen offset:0 nt
v_pk_mul_f32 v[80:81], v[80:81], v[10:11] op_sel_hi:[1,0]
v_pk_mul_f32 v[82:83], v[82:83], v[10:11] op_sel_hi:[1,0]
v_pk_mul_f32 v[84:85], v[84:85], v[10:11] op_sel_hi:[1,0]
v_pk_mul_f32 v[86:87], v[86:87], v[10:11] op_sel_hi:[1,0]
v_pk_mul_f32 v[88:89], v[88:89], v[10:11] op_sel_hi:[1,0]
v_pk_mul_f32 v[90:91], v[90:91], v[10:11] op_sel_hi:[1,0]
v_pk_mul_f32 v[92:93], v[92:93], v[10:11] op_sel_hi:[1,0]
v_pk_mul_f32 v[94:95], v[94:95], v[10:11] op_sel_hi:[1,0]
v_pk_mul_f32 v[96:97], v[96:97], v[10:11] op_sel_hi:[1,0]
v_pk_mul_f32 v[98:99], v[98:99], v[10:11] op_sel_hi:[1,0]
v_pk_mul_f32 v[100:101], v[100:101], v[10:11] op_sel_hi:[1,0]
v_pk_mul_f32 v[102:103], v[102:103], v[10:11] op_sel_hi:[1,0]
v_pk_mul_f32 v[104:105], v[104:105], v[10:11] op_sel_hi:[1,0]
v_pk_mul_f32 v[106:107], v[106:107], v[10:11] op_sel_hi:[1,0]
v_pk_mul_f32 v[108:109], v[108:109], v[10:11] op_sel_hi:[1,0]
v_pk_mul_f32 v[110:111], v[110:111], v[10:11] op_sel_hi:[1,0]
s_waitcnt vmcnt(4)
buffer_load_dwordx4 v[140:143], v2, s[20:23], s71 offen offset:0 nt
s_waitcnt vmcnt(4)
buffer_load_dwordx4 v[168:171], v2, s[20:23], s70 offen offset:256 nt
s_waitcnt vmcnt(4)
buffer_load_dwordx4 v[172:175], v2, s[20:23], s71 offen offset:256 nt
s_mov_b32 s64, s58
s_bitcmp1_b32 s43, 0
s_cselect_b32 s65, 0x96000, 0
s_xor_b32 s64, s64, s65
s_bitcmp1_b32 s43, 1
s_cselect_b32 s65, 0x38000, 0
s_xor_b32 s64, s64, s65
s_bitcmp1_b32 s43, 2
s_cselect_b32 s65, 0x96800, 0
s_xor_b32 s64, s64, s65
s_bitcmp1_b32 s43, 3
s_cselect_b32 s65, 0x94800, 0
s_xor_b32 s64, s64, s65
s_xor_b32 s65, s64, 0x2a0000
s_xor_b32 s66, s64, 0x212000
s_xor_b32 s67, s65, 0x212000
s_xor_b32 s68, s64, 0x202000
s_xor_b32 s69, s65, 0x202000
s_xor_b32 s70, s66, 0x202000
s_xor_b32 s71, s67, 0x202000
s_add_u32 s43, s43, 1
s_add_u32 m0, s59, 0
s_waitcnt vmcnt(4)
buffer_load_dwordx4 v1, s[16:19], s64 offen offset:0 nt lds
s_add_u32 s26, s26, 1
v_mov_b32 v242, s26
s_mov_b64 exec, 1
buffer_store_dword v242, off, s[32:35], s25
s_mov_b64 exec, 0xffffffff
buffer_load_dword v255, v248, s[32:35], 0 offen sc1
s_mov_b64 exec, -1
s_add_u32 m0, s59, 2112
s_waitcnt vmcnt(6)
buffer_load_dwordx4 v1, s[16:19], s65 offen offset:0 nt lds
s_add_u32 m0, s59, 32
s_waitcnt vmcnt(6)
buffer_load_dwordx4 v1, s[16:19], s64 offen offset:1024 nt lds
s_add_u32 m0, s59, 2144
s_waitcnt vmcnt(6)
buffer_load_dwordx4 v1, s[16:19], s65 offen offset:1024 nt lds
s_add_u32 m0, s59, 4224
s_waitcnt vmcnt(6)
buffer_load_dwordx4 v1, s[16:19], s66 offen offset:0 nt lds
v_perm_b32 v32, v116, v112, s47
v_perm_b32 v36, v116, v112, s48
v_perm_b32 v33, v124, v120, s47
v_perm_b32 v37, v124, v120, s48
v_perm_b32 v34, v132, v128, s47
v_perm_b32 v38, v132, v128, s48
v_perm_b32 v35, v140, v136, s47
v_perm_b32 v39, v140, v136, s48
v_perm_b32 v40, v117, v113, s47
v_perm_b32 v44, v117, v113, s48
v_perm_b32 v41, v125, v121, s47
v_perm_b32 v45, v125, v121, s48
v_perm_b32 v42, v133, v129, s47
v_perm_b32 v46, v133, v129, s48
v_perm_b32 v43, v141, v137, s47
v_perm_b32 v47, v141, v137, s48
v_mfma_f32_16x16x32_bf16 v[48:51], v[32:35], v[24:27], v[48:51]
v_mfma_f32_16x16x32_bf16 v[52:55], v[36:39], v[24:27], v[52:55]
s_add_u32 m0, s59, 6336
s_waitcnt vmcnt(6)
buffer_load_dwordx4 v1, s[16:19], s67 offen offset:0 nt lds
v_perm_b32 v32, v118, v114, s47
v_perm_b32 v36, v118, v114, s48
v_perm_b32 v33, v126, v122, s47
v_perm_b32 v37, v126, v122, s48
v_perm_b32 v34, v134, v130, s47
v_perm_b32 v38, v134, v130, s48
v_perm_b32 v35, v142, v138, s47
v_perm_b32 v39, v142, v138, s48
v_mfma_f32_16x16x32_bf16 v[56:59], v[40:43], v[24:27], v[56:59]
v_mfma_f32_16x16x32_bf16 v[60:63], v[44:47], v[24:27], v[60:63]
s_add_u32 m0, s59, 4256
s_waitcnt vmcnt(4)
buffer_load_dwordx4 v1, s[16:19], s66 offen offset:1024 nt lds
v_subrev_u32 v255, s26, v255
v_cmp_gt_u32 s[60:61], 32, v255
s_nop 0
s_and_b32 s50, s60, 0xffffffff
s_bcnt1_i32_b32 s50, s50
v_add_u32 v255, 32, v255
v_cmp_gt_u32 s[60:61], 32, v255
s_nop 0
s_and_b32 s49, s60, 0xffffffff
s_bcnt1_i32_b32 s49, s49
s_cmp_ge_u32 s49, s82
s_cselect_b32 s51, 1, 0
s_cmp_ge_i32 s50, s83
s_cselect_b32 s51, 2, s51
v_mov_b32 v242, s51
s_mov_b64 exec, 1
ds_write_b32 v250, v242 offset:8
s_mov_b64 exec, -1
ds_read_b32 v30, v251 offset:8
v_perm_b32 v40, v119, v115, s47
v_perm_b32 v44, v119, v115, s48
v_perm_b32 v41, v127, v123, s47
v_perm_b32 v45, v127, v123, s48
v_perm_b32 v42, v135, v131, s47
v_perm_b32 v46, v135, v131, s48
v_perm_b32 v43, v143, v139, s47
v_perm_b32 v47, v143, v139, s48
v_mfma_f32_16x16x32_bf16 v[64:67], v[32:35], v[24:27], v[64:67]
v_mfma_f32_16x16x32_bf16 v[68:71], v[36:39], v[24:27], v[68:71]
s_add_u32 m0, s59, 6368
s_waitcnt vmcnt(4)
buffer_load_dwordx4 v1, s[16:19], s67 offen offset:1024 nt lds
s_waitcnt lgkmcnt(0)
v_readfirstlane_b32 s24, v30
s_nop 0
s_bitcmp1_b32 s24, 1
s_cselect_b64 vcc, -1, 0
v_perm_b32 v32, v148, v144, s47
v_perm_b32 v36, v148, v144, s48
v_perm_b32 v33, v156, v152, s47
v_perm_b32 v37, v156, v152, s48
v_perm_b32 v34, v164, v160, s47
v_perm_b32 v38, v164, v160, s48
v_perm_b32 v35, v172, v168, s47
v_perm_b32 v39, v172, v168, s48
v_mfma_f32_16x16x32_bf16 v[72:75], v[40:43], v[24:27], v[72:75]
v_mfma_f32_16x16x32_bf16 v[76:79], v[44:47], v[24:27], v[76:79]
s_add_u32 m0, s59, 8448
s_cbranch_vccnz L_w17
s_waitcnt vmcnt(4)
s_bitcmp1_b32 s24, 0
s_cbranch_scc0 L_w17
s_waitcnt vmcnt(3)
L_w17:
buffer_load_dwordx4 v1, s[16:19], s68 offen offset:0 nt lds
v_perm_b32 v40, v149, v145, s47
v_perm_b32 v44, v149, v145, s48
v_perm_b32 v41, v157, v153, s47
v_perm_b32 v45, v157, v153, s48
v_perm_b32 v42, v165, v161, s47
v_perm_b32 v46, v165, v161, s48
v_perm_b32 v43, v173, v169, s47
v_perm_b32 v47, v173, v169, s48
v_mfma_f32_16x16x32_bf16 v[80:83], v[32:35], v[24:27], v[80:83]
v_mfma_f32_16x16x32_bf16 v[84:87], v[36:39], v[24:27], v[84:87]
s_add_u32 m0, s59, 10560
s_waitcnt vmcnt(5)
s_cbranch_vccnz L_w18
s_waitcnt vmcnt(4)
s_bitcmp1_b32 s24, 0
s_cbranch_scc0 L_w18
s_waitcnt vmcnt(3)
L_w18:
buffer_load_dwordx4 v1, s[16:19], s69 offen offset:0 nt lds
v_perm_b32 v32, v150, v146, s47
v_perm_b32 v36, v150, v146, s48
v_perm_b32 v33, v158, v154, s47
v_perm_b32 v37, v158, v154, s48
v_perm_b32 v34, v166, v162, s47
v_perm_b32 v38, v166, v162, s48
v_perm_b32 v35, v174, v170, s47
v_perm_b32 v39, v174, v170, s48
v_mfma_f32_16x16x32_bf16 v[88:91], v[40:43], v[24:27], v[88:91]
v_mfma_f32_16x16x32_bf16 v[92:95], v[44:47], v[24:27], v[92:95]
s_add_u32 m0, s59, 8480
s_waitcnt vmcnt(5)
s_cbranch_vccnz L_w19
s_waitcnt vmcnt(4)
s_bitcmp1_b32 s24, 0
s_cbranch_scc0 L_w19
s_waitcnt vmcnt(3)
L_w19:
buffer_load_dwordx4 v1, s[16:19], s68 offen offset:1024 nt lds
v_perm_b32 v40, v151, v147, s47
v_perm_b32 v44, v151, v147, s48
v_perm_b32 v41, v159, v155, s47
v_perm_b32 v45, v159, v155, s48
v_perm_b32 v42, v167, v163, s47
v_perm_b32 v46, v167, v163, s48
v_perm_b32 v43, v175, v171, s47
v_perm_b32 v47, v175, v171, s48
v_mfma_f32_16x16x32_bf16 v[96:99], v[32:35], v[24:27], v[96:99]
v_mfma_f32_16x16x32_bf16 v[100:103], v[36:39], v[24:27], v[100:103]
s_add_u32 m0, s59, 10592
s_waitcnt vmcnt(5)
s_cbranch_vccnz L_w20
s_waitcnt vmcnt(4)
s_bitcmp1_b32 s24, 0
s_cbranch_scc0 L_w20
s_waitcnt vmcnt(3)
L_w20:
buffer_load_dwordx4 v1, s[16:19], s69 offen offset:1024 nt lds
v_mfma_f32_16x16x32_bf16 v[104:107], v[40:43], v[24:27], v[104:107]
v_mfma_f32_16x16x32_bf16 v[108:111], v[44:47], v[24:27], v[108:111]
s_add_u32 m0, s59, 12672
s_waitcnt vmcnt(5)
s_cbranch_vccnz L_w21
s_waitcnt vmcnt(4)
s_bitcmp1_b32 s24, 0
s_cbranch_scc0 L_w21
s_waitcnt vmcnt(3)
L_w21:
buffer_load_dwordx4 v1, s[16:19], s70 offen offset:0 nt lds
s_add_u32 m0, s59, 14784
s_waitcnt vmcnt(5)
s_cbranch_vccnz L_w22
s_waitcnt vmcnt(4)
s_bitcmp1_b32 s24, 0
s_cbranch_scc0 L_w22
s_waitcnt vmcnt(3)
L_w22:
buffer_load_dwordx4 v1, s[16:19], s71 offen offset:0 nt lds
s_add_u32 m0, s59, 12704
s_waitcnt vmcnt(5)
s_cbranch_vccnz L_w23
s_waitcnt vmcnt(4)
s_bitcmp1_b32 s24, 0
s_cbranch_scc0 L_w23
s_waitcnt vmcnt(3)
L_w23:
buffer_load_dwordx4 v1, s[16:19], s70 offen offset:1024 nt lds
s_add_u32 m0, s59, 14816
s_waitcnt vmcnt(5)
s_cbranch_vccnz L_w24
s_waitcnt vmcnt(4)
s_bitcmp1_b32 s24, 0
s_cbranch_scc0 L_w24
s_waitcnt vmcnt(3)
L_w24:
buffer_load_dwordx4 v1, s[16:19], s71 offen offset:1024 nt lds
buffer_load_dwordx4 v[112:115], v2, s[20:23], s64 offen offset:0 nt
buffer_load_dwordx4 v[116:119], v2, s[20:23], s65 offen offset:0 nt
s_waitcnt vmcnt(7)
buffer_load_dwordx4 v[144:147], v2, s[20:23], s64 offen offset:256 nt
s_waitcnt vmcnt(7)
buffer_load_dwordx4 v[148:151], v2, s[20:23], s65 offen offset:256 nt
s_waitcnt vmcnt(7)
buffer_load_dwordx4 v[120:123], v2, s[20:23], s66 offen offset:0 nt
s_waitcnt vmcnt(7)
buffer_load_dwordx4 v[124:127], v2, s[20:23], s67 offen offset:0 nt
s_waitcnt vmcnt(7)
buffer_load_dwordx4 v[152:155], v2, s[20:23], s66 offen offset:256 nt
s_waitcnt vmcnt(7)
buffer_load_dwordx4 v[156:159], v2, s[20:23], s67 offen offset:256 nt
ds_read_b128 v[176:179], v4 offset:0
ds_read_b128 v[180:183], v5 offset:0
ds_read_b128 v[184:187], v6 offset:0
ds_read_b128 v[188:191], v7 offset:0
ds_read_b128 v[192:195], v4 offset:256
ds_read_b128 v[196:199], v5 offset:256
ds_read_b128 v[200:203], v6 offset:256
ds_read_b128 v[204:207], v7 offset:256
ds_read_b128 v[208:211], v4 offset:8448
ds_read_b128 v[212:215], v5 offset:8448
ds_read_b128 v[216:219], v6 offset:8448
ds_read_b128 v[220:223], v7 offset:8448
ds_read_b128 v[224:227], v4 offset:8704
ds_read_b128 v[228:231], v5 offset:8704
ds_read_b128 v[232:235], v6 offset:8704
ds_read_b128 v[236:239], v7 offset:8704
s_waitcnt vmcnt(7)
buffer_load_dwordx4 v[128:131], v2, s[20:23], s68 offen offset:0 nt
s_waitcnt lgkmcnt(8)
v_mfma_f32_16x16x32_bf16 v[16:19], v[176:179], a[0:3], 0
v_mfma_f32_16x16x32_bf16 v[16:19], v[180:183], a[4:7], v[16:19]
v_mfma_f32_16x16x32_bf16 v[16:19], v[184:187], a[8:11], v[16:19]
v_mfma_f32_16x16x32_bf16 v[16:19], v[188:191], a[12:15], v[16:19]
v_mfma_f32_16x16x32_bf16 v[16:19], v[192:195], a[16:19], v[16:19]
v_mfma_f32_16x16x32_bf16 v[16:19], v[196:199], a[20:23], v[16:19]
v_mfma_f32_16x16x32_bf16 v[16:19], v[200:203], a[24:27], v[16:19]
v_mfma_f32_16x16x32_bf16 v[16:19], v[204:207], a[28:31], v[16:19]
s_waitcnt vmcnt(7)
buffer_load_dwordx4 v[132:135], v2, s[20:23], s69 offen offset:0 nt
s_waitcnt lgkmcnt(0)
v_mfma_f32_16x16x32_bf16 v[20:23], v[208:211], a[0:3], 0
v_mfma_f32_16x16x32_bf16 v[20:23], v[212:215], a[4:7], v[20:23]
v_mfma_f32_16x16x32_bf16 v[20:23], v[216:219], a[8:11], v[20:23]
v_mfma_f32_16x16x32_bf16 v[20:23], v[220:223], a[12:15], v[20:23]
v_mfma_f32_16x16x32_bf16 v[20:23], v[224:227], a[16:19], v[20:23]
v_mfma_f32_16x16x32_bf16 v[20:23], v[228:231], a[20:23], v[20:23]
v_mfma_f32_16x16x32_bf16 v[20:23], v[232:235], a[24:27], v[20:23]
v_mfma_f32_16x16x32_bf16 v[20:23], v[236:239], a[28:31], v[20:23]
s_waitcnt vmcnt(7)
buffer_load_dwordx4 v[160:163], v2, s[20:23], s68 offen offset:256 nt
s_nop 7
v_max3_f32 v12, v16, v17, v18
v_max3_f32 v13, v19, v20, v21
v_max3_f32 v12, v12, v22, v23
v_max3_f32 v12, v12, v13, v8
v_mov_b32 v13, v12
s_nop 1
v_permlane16_swap_b32 v12, v13
v_max_f32 v12, v12, v13
v_mov_b32 v13, v12
s_nop 1
v_permlane32_swap_b32 v12, v13
v_max_f32 v12, v12, v13
v_sub_f32 v14, v8, v12
v_mul_f32 v15, s46, v12
v_mul_f32 v14, s46, v14
v_mov_b32 v8, v12
v_exp_f32 v10, v14
s_waitcnt vmcnt(7)
buffer_load_dwordx4 v[164:167], v2, s[20:23], s69 offen offset:256 nt
v_fma_f32 v16, v16, s46, -v15
v_fma_f32 v17, v17, s46, -v15
v_fma_f32 v18, v18, s46, -v15
v_fma_f32 v19, v19, s46, -v15
v_fma_f32 v20, v20, s46, -v15
v_fma_f32 v21, v21, s46, -v15
v_fma_f32 v22, v22, s46, -v15
v_fma_f32 v23, v23, s46, -v15
v_exp_f32 v16, v16
v_exp_f32 v17, v17
v_exp_f32 v18, v18
v_exp_f32 v19, v19
v_exp_f32 v20, v20
v_exp_f32 v21, v21
v_exp_f32 v22, v22
v_exp_f32 v23, v23
s_waitcnt vmcnt(7)
buffer_load_dwordx4 v[136:139], v2, s[20:23], s70 offen offset:0 nt
v_cvt_pk_bf16_f32 v24, v16, v17
v_cvt_pk_bf16_f32 v25, v18, v19
v_cvt_pk_bf16_f32 v26, v20, v21
v_cvt_pk_bf16_f32 v27, v22, v23
v_add_f32 v12, v16, v17
v_add_f32 v13, v18, v19
v_add_f32 v14, v20, v21
v_add_f32 v22, v22, v23
v_add_f32 v12, v12, v13
v_add_f32 v14, v14, v22
v_add_f32 v12, v12, v14
v_fma_f32 v9, v9, v10, v12
s_waitcnt vmcnt(7)
buffer_load_dwordx4 v[140:143], v2, s[20:23], s71 offen offset:0 nt
v_pk_mul_f32 v[48:49], v[48:49], v[10:11] op_sel_hi:[1,0]
v_pk_mul_f32 v[50:51], v[50:51], v[10:11] op_sel_hi:[1,0]
v_pk_mul_f32 v[52:53], v[52:53], v[10:11] op_sel_hi:[1,0]
v_pk_mul_f32 v[54:55], v[54:55], v[10:11] op_sel_hi:[1,0]
v_pk_mul_f32 v[56:57], v[56:57], v[10:11] op_sel_hi:[1,0]
v_pk_mul_f32 v[58:59], v[58:59], v[10:11] op_sel_hi:[1,0]
v_pk_mul_f32 v[60:61], v[60:61], v[10:11] op_sel_hi:[1,0]
v_pk_mul_f32 v[62:63], v[62:63], v[10:11] op_sel_hi:[1,0]
v_pk_mul_f32 v[64:65], v[64:65], v[10:11] op_sel_hi:[1,0]
v_pk_mul_f32 v[66:67], v[66:67], v[10:11] op_sel_hi:[1,0]
v_pk_mul_f32 v[68:69], v[68:69], v[10:11] op_sel_hi:[1,0]
v_pk_mul_f32 v[70:71], v[70:71], v[10:11] op_sel_hi:[1,0]
v_pk_mul_f32 v[72:73], v[72:73], v[10:11] op_sel_hi:[1,0]
v_pk_mul_f32 v[74:75], v[74:75], v[10:11] op_sel_hi:[1,0]
v_pk_mul_f32 v[76:77], v[76:77], v[10:11] op_sel_hi:[1,0]
v_pk_mul_f32 v[78:79], v[78:79], v[10:11] op_sel_hi:[1,0]
s_waitcnt vmcnt(7)
buffer_load_dwordx4 v[168:171], v2, s[20:23], s70 offen offset:256 nt
v_mov_b32 v13, v9
v_add_u32 v29, s59, v253
s_lshl_b32 s49, s40, 9
v_permlane16_swap_b32 v9, v13
s_add_u32 s49, s49, 76032
v_add_f32 v9, v9, v13
v_mov_b32 v13, v9
v_add_u32 v30, s49, v253
v_add_u32 v14, 76032, v253
v_permlane32_swap_b32 v9, v13
v_add_f32 v9, v9, v13
ds_write_b64 v30, v[8:9]
s_waitcnt vmcnt(7)
buffer_load_dwordx4 v[172:175], v2, s[20:23], s71 offen offset:256 nt
v_pk_mul_f32 v[80:81], v[80:81], v[10:11] op_sel_hi:[1,0]
v_pk_mul_f32 v[82:83], v[82:83], v[10:11] op_sel_hi:[1,0]
v_pk_mul_f32 v[84:85], v[84:85], v[10:11] op_sel_hi:[1,0]
v_pk_mul_f32 v[86:87], v[86:87], v[10:11] op_sel_hi:[1,0]
v_pk_mul_f32 v[88:89], v[88:89], v[10:11] op_sel_hi:[1,0]
v_pk_mul_f32 v[90:91], v[90:91], v[10:11] op_sel_hi:[1,0]
v_pk_mul_f32 v[92:93], v[92:93], v[10:11] op_sel_hi:[1,0]
v_pk_mul_f32 v[94:95], v[94:95], v[10:11] op_sel_hi:[1,0]
v_pk_mul_f32 v[96:97], v[96:97], v[10:11] op_sel_hi:[1,0]
v_pk_mul_f32 v[98:99], v[98:99], v[10:11] op_sel_hi:[1,0]
v_pk_mul_f32 v[100:101], v[100:101], v[10:11] op_sel_hi:[1,0]
v_pk_mul_f32 v[102:103], v[102:103], v[10:11] op_sel_hi:[1,0]
v_pk_mul_f32 v[104:105], v[104:105], v[10:11] op_sel_hi:[1,0]
v_pk_mul_f32 v[106:107], v[106:107], v[10:11] op_sel_hi:[1,0]
v_pk_mul_f32 v[108:109], v[108:109], v[10:11] op_sel_hi:[1,0]
v_pk_mul_f32 v[110:111], v[110:111], v[10:11] op_sel_hi:[1,0]
s_mov_b64 exec, 1
buffer_atomic_add v240, v241, s[36:39], 0 offen sc0
s_mov_b64 exec, -1
s_cmp_ge_u32 s40, 2
s_cbranch_scc1 L_c23
s_cmp_eq_u32 s40, 1
s_cbranch_scc1 L_c1
s_waitcnt vmcnt(3)
v_perm_b32 v32, v116, v112, s47
v_perm_b32 v36, v116, v112, s48
v_perm_b32 v33, v124, v120, s47
v_perm_b32 v37, v124, v120, s48
v_perm_b32 v34, v132, v128, s47
v_perm_b32 v38, v132, v128, s48
v_perm_b32 v35, v140, v136, s47
v_perm_b32 v39, v140, v136, s48
v_perm_b32 v40, v117, v113, s47
v_perm_b32 v44, v117, v113, s48
v_perm_b32 v41, v125, v121, s47
v_perm_b32 v45, v125, v121, s48
v_perm_b32 v42, v133, v129, s47
v_perm_b32 v46, v133, v129, s48
v_perm_b32 v43, v141, v137, s47
v_perm_b32 v47, v141, v137, s48
v_mfma_f32_16x16x32_bf16 v[48:51], v[32:35], v[24:27], v[48:51]
v_mfma_f32_16x16x32_bf16 v[52:55], v[36:39], v[24:27], v[52:55]
v_perm_b32 v32, v118, v114, s47
v_perm_b32 v36, v118, v114, s48
v_perm_b32 v33, v126, v122, s47
v_perm_b32 v37, v126, v122, s48
v_perm_b32 v34, v134, v130, s47
v_perm_b32 v38, v134, v130, s48
v_perm_b32 v35, v142, v138, s47
v_perm_b32 v39, v142, v138, s48
v_mfma_f32_16x16x32_bf16 v[56:59], v[40:43], v[24:27], v[56:59]
v_mfma_f32_16x16x32_bf16 v[60:63], v[44:47], v[24:27], v[60:63]
v_perm_b32 v40, v119, v115, s47
v_perm_b32 v44, v119, v115, s48
v_perm_b32 v41, v127, v123, s47
v_perm_b32 v45, v127, v123, s48
v_perm_b32 v42, v135, v131, s47
v_perm_b32 v46, v135, v131, s48
v_perm_b32 v43, v143, v139, s47
v_perm_b32 v47, v143, v139, s48
v_mfma_f32_16x16x32_bf16 v[64:67], v[32:35], v[24:27], v[64:67]
v_mfma_f32_16x16x32_bf16 v[68:71], v[36:39], v[24:27], v[68:71]
s_waitcnt vmcnt(1)
v_perm_b32 v32, v148, v144, s47
v_perm_b32 v36, v148, v144, s48
v_perm_b32 v33, v156, v152, s47
v_perm_b32 v37, v156, v152, s48
v_perm_b32 v34, v164, v160, s47
v_perm_b32 v38, v164, v160, s48
v_perm_b32 v35, v172, v168, s47
v_perm_b32 v39, v172, v168, s48
v_mfma_f32_16x16x32_bf16 v[72:75], v[40:43], v[24:27], v[72:75]
v_mfma_f32_16x16x32_bf16 v[76:79], v[44:47], v[24:27], v[76:79]
v_perm_b32 v40, v149, v145, s47
v_perm_b32 v44, v149, v145, s48
v_perm_b32 v41, v157, v153, s47
v_perm_b32 v45, v157, v153, s48
v_perm_b32 v42, v165, v161, s47
v_perm_b32 v46, v165, v161, s48
v_perm_b32 v43, v173, v169, s47
v_perm_b32 v47, v173, v169, s48
v_mfma_f32_16x16x32_bf16 v[80:83], v[32:35], v[24:27], v[80:83]
v_mfma_f32_16x16x32_bf16 v[84:87], v[36:39], v[24:27], v[84:87]
ds_write_b64 v29, v[50:51] offset:512
ds_write_b64 v29, v[54:55] offset:1536
v_perm_b32 v32, v150, v146, s47
v_perm_b32 v36, v150, v146, s48
v_perm_b32 v33, v158, v154, s47
v_perm_b32 v37, v158, v154, s48
v_perm_b32 v34, v166, v162, s47
v_perm_b32 v38, v166, v162, s48
v_perm_b32 v35, v174, v170, s47
v_perm_b32 v39, v174, v170, s48
v_mfma_f32_16x16x32_bf16 v[88:91], v[40:43], v[24:27], v[88:91]
v_mfma_f32_16x16x32_bf16 v[92:95], v[44:47], v[24:27], v[92:95]
ds_write_b64 v29, v[58:59] offset:2560
ds_write_b64 v29, v[62:63] offset:3584
v_perm_b32 v40, v151, v147, s47
v_perm_b32 v44, v151, v147, s48
v_perm_b32 v41, v159, v155, s47
v_perm_b32 v45, v159, v155, s48
v_perm_b32 v42, v167, v163, s47
v_perm_b32 v46, v167, v163, s48
v_perm_b32 v43, v175, v171, s47
v_perm_b32 v47, v175, v171, s48
v_mfma_f32_16x16x32_bf16 v[96:99], v[32:35], v[24:27], v[96:99]
v_mfma_f32_16x16x32_bf16 v[100:103], v[36:39], v[24:27], v[100:103]
ds_write_b64 v29, v[66:67] offset:4608
ds_write_b64 v29, v[70:71] offset:5632
v_mfma_f32_16x16x32_bf16 v[104:107], v[40:43], v[24:27], v[104:107]
v_mfma_f32_16x16x32_bf16 v[108:111], v[44:47], v[24:27], v[108:111]
ds_write_b64 v29, v[74:75] offset:6656
ds_write_b64 v29, v[78:79] offset:7680
ds_write_b64 v29, v[80:81] offset:8192
ds_write_b64 v29, v[82:83] offset:8704
ds_write_b64 v29, v[84:85] offset:9216
ds_write_b64 v29, v[86:87] offset:9728
ds_write_b64 v29, v[88:89] offset:10240
ds_write_b64 v29, v[90:91] offset:10752
ds_write_b64 v29, v[92:93] offset:11264
ds_write_b64 v29, v[94:95] offset:11776
s_nop 0
ds_write_b64 v29, v[96:97] offset:12288
ds_write_b64 v29, v[98:99] offset:12800
ds_write_b64 v29, v[100:101] offset:13312
ds_write_b64 v29, v[102:103] offset:13824
ds_write_b64 v29, v[104:105] offset:14336
ds_write_b64 v29, v[106:107] offset:14848
ds_write_b64 v29, v[108:109] offset:15360
ds_write_b64 v29, v[110:111] offset:15872
v_add_u32 v29, 33792, v253
s_waitcnt vmcnt(0)
s_mov_b64 exec, 1
ds_write_b32 v250, v240
s_mov_b64 exec, -1
s_waitcnt lgkmcnt(0)
s_barrier
ds_read_b32 v30, v251
ds_read_b64 v[16:17], v14 offset:0
ds_read_b64 v[18:19], v14 offset:512
ds_read_b64 v[20:21], v14 offset:1024
ds_read_b64 v[22:23], v14 offset:1536
ds_read_b64 v[112:113], v253 offset:16896
ds_read_b64 v[114:115], v253 offset:17920
ds_read_b64 v[116:117], v253 offset:18944
ds_read_b64 v[118:119], v253 offset:19968
ds_read_b64 v[120:121], v253 offset:20992
ds_read_b64 v[122:123], v253 offset:22016
ds_read_b64 v[124:125], v253 offset:23040
ds_read_b64 v[126:127], v253 offset:24064
s_waitcnt lgkmcnt(12)
v_readfirstlane_b32 s44, v30
s_nop 0
s_cmp_eq_u32 s44, 3
s_cselect_b32 s77, 1, 0
s_cbranch_scc0 L_nf0
buffer_load_dwordx3 v[228:230], v249, s[32:35], s73 offen sc1
buffer_load_dwordx3 v[232:234], v249, s[32:35], s74 offen sc1
buffer_load_dwordx3 v[236:238], v249, s[32:35], s75 offen sc1
buffer_load_dwordx4 v[184:187], v252, s[32:35], s53 offen offset:0 sc1
buffer_load_dwordx4 v[188:191], v252, s[32:35], s53 offen offset:1024 sc1
buffer_load_dwordx4 v[192:195], v252, s[32:35], s54 offen offset:0 sc1
buffer_load_dwordx4 v[196:199], v252, s[32:35], s54 offen offset:1024 sc1
buffer_load_dwordx4 v[200:203], v252, s[32:35], s55 offen offset:0 sc1
buffer_load_dwordx4 v[204:207], v252, s[32:35], s55 offen offset:1024 sc1
L_nf0:
s_waitcnt lgkmcnt(8)
ds_read_b64 v[128:129], v29 offset:0
ds_read_b64 v[130:131], v29 offset:1024
ds_read_b64 v[132:133], v29 offset:2048
ds_read_b64 v[134:135], v29 offset:3072
ds_read_b64 v[136:137], v29 offset:4096
ds_read_b64 v[138:139], v29 offset:5120
ds_read_b64 v[140:141], v29 offset:6144
v_max3_f32 v8, v16, v18, v20
v_max_f32 v8, v8, v22
v_sub_f32 v24, v16, v8
v_sub_f32 v25, v18, v8
v_sub_f32 v26, v20, v8
v_sub_f32 v27, v22, v8
v_mul_f32 v24, s46, v24
v_mul_f32 v25, s46, v25
v_mul_f32 v26, s46, v26
v_mul_f32 v27, s46, v27
v_exp_f32 v24, v24
v_exp_f32 v25, v25
v_exp_f32 v26, v26
v_exp_f32 v27, v27
s_nop 0
v_mul_f32 v17, v24, v17
v_mul_f32 v19, v25, v19
v_mul_f32 v21, v26, v21
v_mul_f32 v23, v27, v23
v_add_f32 v17, v17, v19
v_add_f32 v21, v21, v23
v_add_f32 v9, v17, v21
v_pk_mul_f32 v[32:33], v[48:49], v[24:25] op_sel:[0,0] op_sel_hi:[1,0]
v_pk_mul_f32 v[34:35], v[52:53], v[24:25] op_sel:[0,0] op_sel_hi:[1,0]
v_pk_mul_f32 v[36:37], v[56:57], v[24:25] op_sel:[0,0] op_sel_hi:[1,0]
v_pk_mul_f32 v[38:39], v[60:61], v[24:25] op_sel:[0,0] op_sel_hi:[1,0]
v_pk_mul_f32 v[40:41], v[64:65], v[24:25] op_sel:[0,0] op_sel_hi:[1,0]
v_pk_mul_f32 v[42:43], v[68:69], v[24:25] op_sel:[0,0] op_sel_hi:[1,0]
v_pk_mul_f32 v[44:45], v[72:73], v[24:25] op_sel:[0,0] op_sel_hi:[1,0]
v_pk_mul_f32 v[46:47], v[76:77], v[24:25] op_sel:[0,0] op_sel_hi:[1,0]
s_waitcnt lgkmcnt(7)
ds_read_b64 v[142:143], v29 offset:7168
ds_read_b64 v[144:145], v29 offset:16896
ds_read_b64 v[146:147], v29 offset:17920
ds_read_b64 v[148:149], v29 offset:18944
ds_read_b64 v[150:151], v29 offset:19968
ds_read_b64 v[152:153], v29 offset:20992
ds_read_b64 v[154:155], v29 offset:22016
ds_read_b64 v[156:157], v29 offset:23040
v_pk_fma_f32 v[32:33], v[112:113], v[24:25], v[32:33] op_sel:[0,1,0] op_sel_hi:[1,1,1]
v_pk_fma_f32 v[34:35], v[114:115], v[24:25], v[34:35] op_sel:[0,1,0] op_sel_hi:[1,1,1]
v_pk_fma_f32 v[36:37], v[116:117], v[24:25], v[36:37] op_sel:[0,1,0] op_sel_hi:[1,1,1]
v_pk_fma_f32 v[38:39], v[118:119], v[24:25], v[38:39] op_sel:[0,1,0] op_sel_hi:[1,1,1]
v_pk_fma_f32 v[40:41], v[120:121], v[24:25], v[40:41] op_sel:[0,1,0] op_sel_hi:[1,1,1]
v_pk_fma_f32 v[42:43], v[122:123], v[24:25], v[42:43] op_sel:[0,1,0] op_sel_hi:[1,1,1]
v_pk_fma_f32 v[44:45], v[124:125], v[24:25], v[44:45] op_sel:[0,1,0] op_sel_hi:[1,1,1]
v_pk_fma_f32 v[46:47], v[126:127], v[24:25], v[46:47] op_sel:[0,1,0] op_sel_hi:[1,1,1]
s_waitcnt lgkmcnt(7)
ds_read_b64 v[158:159], v29 offset:24064
v_pk_fma_f32 v[32:33], v[128:129], v[26:27], v[32:33] op_sel:[0,0,0] op_sel_hi:[1,0,1]
v_pk_fma_f32 v[34:35], v[130:131], v[26:27], v[34:35] op_sel:[0,0,0] op_sel_hi:[1,0,1]
v_pk_fma_f32 v[36:37], v[132:133], v[26:27], v[36:37] op_sel:[0,0,0] op_sel_hi:[1,0,1]
v_pk_fma_f32 v[38:39], v[134:135], v[26:27], v[38:39] op_sel:[0,0,0] op_sel_hi:[1,0,1]
v_pk_fma_f32 v[40:41], v[136:137], v[26:27], v[40:41] op_sel:[0,0,0] op_sel_hi:[1,0,1]
v_pk_fma_f32 v[42:43], v[138:139], v[26:27], v[42:43] op_sel:[0,0,0] op_sel_hi:[1,0,1]
v_pk_fma_f32 v[44:45], v[140:141], v[26:27], v[44:45] op_sel:[0,0,0] op_sel_hi:[1,0,1]
v_pk_fma_f32 v[46:47], v[142:143], v[26:27], v[46:47] op_sel:[0,0,0] op_sel_hi:[1,0,1]
s_waitcnt lgkmcnt(0)
v_pk_fma_f32 v[32:33], v[144:145], v[26:27], v[32:33] op_sel:[0,1,0] op_sel_hi:[1,1,1]
v_pk_fma_f32 v[34:35], v[146:147], v[26:27], v[34:35] op_sel:[0,1,0] op_sel_hi:[1,1,1]
v_pk_fma_f32 v[36:37], v[148:149], v[26:27], v[36:37] op_sel:[0,1,0] op_sel_hi:[1,1,1]
v_pk_fma_f32 v[38:39], v[150:151], v[26:27], v[38:39] op_sel:[0,1,0] op_sel_hi:[1,1,1]
v_pk_fma_f32 v[40:41], v[152:153], v[26:27], v[40:41] op_sel:[0,1,0] op_sel_hi:[1,1,1]
v_pk_fma_f32 v[42:43], v[154:155], v[26:27], v[42:43] op_sel:[0,1,0] op_sel_hi:[1,1,1]
v_pk_fma_f32 v[44:45], v[156:157], v[26:27], v[44:45] op_sel:[0,1,0] op_sel_hi:[1,1,1]
v_pk_fma_f32 v[46:47], v[158:159], v[26:27], v[46:47] op_sel:[0,1,0] op_sel_hi:[1,1,1]
s_branch L_cj
L_c1:
s_waitcnt vmcnt(3)
v_perm_b32 v32, v116, v112, s47
v_perm_b32 v36, v116, v112, s48
v_perm_b32 v33, v124, v120, s47
v_perm_b32 v37, v124, v120, s48
v_perm_b32 v34, v132, v128, s47
v_perm_b32 v38, v132, v128, s48
v_perm_b32 v35, v140, v136, s47
v_perm_b32 v39, v140, v136, s48
v_perm_b32 v40, v117, v113, s47
v_perm_b32 v44, v117, v113, s48
v_perm_b32 v41, v125, v121, s47
v_perm_b32 v45, v125, v121, s48
v_perm_b32 v42, v133, v129, s47
v_perm_b32 v46, v133, v129, s48
v_perm_b32 v43, v141, v137, s47
v_perm_b32 v47, v141, v137, s48
v_mfma_f32_16x16x32_bf16 v[48:51], v[32:35], v[24:27], v[48:51]
v_mfma_f32_16x16x32_bf16 v[52:55], v[36:39], v[24:27], v[52:55]
v_perm_b32 v32, v118, v114, s47
v_perm_b32 v36, v118, v114, s48
v_perm_b32 v33, v126, v122, s47
v_perm_b32 v37, v126, v122, s48
v_perm_b32 v34, v134, v130, s47
v_perm_b32 v38, v134, v130, s48
v_perm_b32 v35, v142, v138, s47
v_perm_b32 v39, v142, v138, s48
v_mfma_f32_16x16x32_bf16 v[56:59], v[40:43], v[24:27], v[56:59]
v_mfma_f32_16x16x32_bf16 v[60:63], v[44:47], v[24:27], v[60:63]
v_perm_b32 v40, v119, v115, s47
v_perm_b32 v44, v119, v115, s48
v_perm_b32 v41, v127, v123, s47
v_perm_b32 v45, v127, v123, s48
v_perm_b32 v42, v135, v131, s47
v_perm_b32 v46, v135, v131, s48
v_perm_b32 v43, v143, v139, s47
v_perm_b32 v47, v143, v139, s48
v_mfma_f32_16x16x32_bf16 v[64:67], v[32:35], v[24:27], v[64:67]
v_mfma_f32_16x16x32_bf16 v[68:71], v[36:39], v[24:27], v[68:71]
s_waitcnt vmcnt(1)
v_perm_b32 v32, v148, v144, s47
v_perm_b32 v36, v148, v144, s48
v_perm_b32 v33, v156, v152, s47
v_perm_b32 v37, v156, v152, s48
v_perm_b32 v34, v164, v160, s47
v_perm_b32 v38, v164, v160, s48
v_perm_b32 v35, v172, v168, s47
v_perm_b32 v39, v172, v168, s48
v_mfma_f32_16x16x32_bf16 v[72:75], v[40:43], v[24:27], v[72:75]
v_mfma_f32_16x16x32_bf16 v[76:79], v[44:47], v[24:27], v[76:79]
v_perm_b32 v40, v149, v145, s47
v_perm_b32 v44, v149, v145, s48
v_perm_b32 v41, v157, v153, s47
v_perm_b32 v45, v157, v153, s48
v_perm_b32 v42, v165, v161, s47
v_perm_b32 v46, v165, v161, s48
v_perm_b32 v43, v173, v169, s47
v_perm_b32 v47, v173, v169, s48
v_mfma_f32_16x16x32_bf16 v[80:83], v[32:35], v[24:27], v[80:83]
v_mfma_f32_16x16x32_bf16 v[84:87], v[36:39], v[24:27], v[84:87]
ds_write_b64 v29, v[48:49] offset:0
ds_write_b64 v29, v[52:53] offset:1024
v_perm_b32 v32, v150, v146, s47
v_perm_b32 v36, v150, v146, s48
v_perm_b32 v33, v158, v154, s47
v_perm_b32 v37, v158, v154, s48
v_perm_b32 v34, v166, v162, s47
v_perm_b32 v38, v166, v162, s48
v_perm_b32 v35, v174, v170, s47
v_perm_b32 v39, v174, v170, s48
v_mfma_f32_16x16x32_bf16 v[88:91], v[40:43], v[24:27], v[88:91]
v_mfma_f32_16x16x32_bf16 v[92:95], v[44:47], v[24:27], v[92:95]
ds_write_b64 v29, v[56:57] offset:2048
ds_write_b64 v29, v[60:61] offset:3072
v_perm_b32 v40, v151, v147, s47
v_perm_b32 v44, v151, v147, s48
v_perm_b32 v41, v159, v155, s47
v_perm_b32 v45, v159, v155, s48
v_perm_b32 v42, v167, v163, s47
v_perm_b32 v46, v167, v163, s48
v_perm_b32 v43, v175, v171, s47
v_perm_b32 v47, v175, v171, s48
v_mfma_f32_16x16x32_bf16 v[96:99], v[32:35], v[24:27], v[96:99]
v_mfma_f32_16x16x32_bf16 v[100:103], v[36:39], v[24:27], v[100:103]
ds_write_b64 v29, v[64:65] offset:4096
ds_write_b64 v29, v[68:69] offset:5120
v_mfma_f32_16x16x32_bf16 v[104:107], v[40:43], v[24:27], v[104:107]
v_mfma_f32_16x16x32_bf16 v[108:111], v[44:47], v[24:27], v[108:111]
ds_write_b64 v29, v[72:73] offset:6144
ds_write_b64 v29, v[76:77] offset:7168
ds_write_b64 v29, v[80:81] offset:8192
ds_write_b64 v29, v[82:83] offset:8704
ds_write_b64 v29, v[84:85] offset:9216
ds_write_b64 v29, v[86:87] offset:9728
ds_write_b64 v29, v[88:89] offset:10240
ds_write_b64 v29, v[90:91] offset:10752
ds_write_b64 v29, v[92:93] offset:11264
ds_write_b64 v29, v[94:95] offset:11776
s_nop 0
ds_write_b64 v29, v[96:97] offset:12288
ds_write_b64 v29, v[98:99] offset:12800
ds_write_b64 v29, v[100:101] offset:13312
ds_write_b64 v29, v[102:103] offset:13824
ds_write_b64 v29, v[104:105] offset:14336
ds_write_b64 v29, v[106:107] offset:14848
ds_write_b64 v29, v[108:109] offset:15360
ds_write_b64 v29, v[110:111] offset:15872
v_add_u32 v29, 33792, v253
s_waitcnt vmcnt(0)
s_mov_b64 exec, 1
ds_write_b32 v250, v240
s_mov_b64 exec, -1
s_waitcnt lgkmcnt(0)
s_barrier
ds_read_b32 v30, v251
ds_read_b64 v[16:17], v14 offset:0
ds_read_b64 v[18:19], v14 offset:512
ds_read_b64 v[20:21], v14 offset:1024
ds_read_b64 v[22:23], v14 offset:1536
ds_read_b64 v[112:113], v253 offset:512
ds_read_b64 v[114:115], v253 offset:1536
ds_read_b64 v[116:117], v253 offset:2560
ds_read_b64 v[118:119], v253 offset:3584
ds_read_b64 v[120:121], v253 offset:4608
ds_read_b64 v[122:123], v253 offset:5632
ds_read_b64 v[124:125], v253 offset:6656
ds_read_b64 v[126:127], v253 offset:7680
s_waitcnt lgkmcnt(12)
v_readfirstlane_b32 s44, v30
s_nop 0
s_cmp_eq_u32 s44, 3
s_cselect_b32 s77, 1, 0
s_cbranch_scc0 L_nf1
buffer_load_dwordx3 v[228:230], v249, s[32:35], s73 offen sc1
buffer_load_dwordx3 v[232:234], v249, s[32:35], s74 offen sc1
buffer_load_dwordx3 v[236:238], v249, s[32:35], s75 offen sc1
buffer_load_dwordx4 v[184:187], v252, s[32:35], s53 offen offset:0 sc1
buffer_load_dwordx4 v[188:191], v252, s[32:35], s53 offen offset:1024 sc1
buffer_load_dwordx4 v[192:195], v252, s[32:35], s54 offen offset:0 sc1
buffer_load_dwordx4 v[196:199], v252, s[32:35], s54 offen offset:1024 sc1
buffer_load_dwordx4 v[200:203], v252, s[32:35], s55 offen offset:0 sc1
buffer_load_dwordx4 v[204:207], v252, s[32:35], s55 offen offset:1024 sc1
L_nf1:
s_waitcnt lgkmcnt(8)
ds_read_b64 v[128:129], v29 offset:512
ds_read_b64 v[130:131], v29 offset:1536
ds_read_b64 v[132:133], v29 offset:2560
ds_read_b64 v[134:135], v29 offset:3584
ds_read_b64 v[136:137], v29 offset:4608
ds_read_b64 v[138:139], v29 offset:5632
ds_read_b64 v[140:141], v29 offset:6656
v_max3_f32 v8, v16, v18, v20
v_max_f32 v8, v8, v22
v_sub_f32 v24, v16, v8
v_sub_f32 v25, v18, v8
v_sub_f32 v26, v20, v8
v_sub_f32 v27, v22, v8
v_mul_f32 v24, s46, v24
v_mul_f32 v25, s46, v25
v_mul_f32 v26, s46, v26
v_mul_f32 v27, s46, v27
v_exp_f32 v24, v24
v_exp_f32 v25, v25
v_exp_f32 v26, v26
v_exp_f32 v27, v27
s_nop 0
v_mul_f32 v17, v24, v17
v_mul_f32 v19, v25, v19
v_mul_f32 v21, v26, v21
v_mul_f32 v23, v27, v23
v_add_f32 v17, v17, v19
v_add_f32 v21, v21, v23
v_add_f32 v9, v17, v21
v_pk_mul_f32 v[32:33], v[50:51], v[24:25] op_sel:[0,1] op_sel_hi:[1,1]
v_pk_mul_f32 v[34:35], v[54:55], v[24:25] op_sel:[0,1] op_sel_hi:[1,1]
v_pk_mul_f32 v[36:37], v[58:59], v[24:25] op_sel:[0,1] op_sel_hi:[1,1]
v_pk_mul_f32 v[38:39], v[62:63], v[24:25] op_sel:[0,1] op_sel_hi:[1,1]
v_pk_mul_f32 v[40:41], v[66:67], v[24:25] op_sel:[0,1] op_sel_hi:[1,1]
v_pk_mul_f32 v[42:43], v[70:71], v[24:25] op_sel:[0,1] op_sel_hi:[1,1]
v_pk_mul_f32 v[44:45], v[74:75], v[24:25] op_sel:[0,1] op_sel_hi:[1,1]
v_pk_mul_f32 v[46:47], v[78:79], v[24:25] op_sel:[0,1] op_sel_hi:[1,1]
s_waitcnt lgkmcnt(7)
ds_read_b64 v[142:143], v29 offset:7680
ds_read_b64 v[144:145], v29 offset:17408
ds_read_b64 v[146:147], v29 offset:18432
ds_read_b64 v[148:149], v29 offset:19456
ds_read_b64 v[150:151], v29 offset:20480
ds_read_b64 v[152:153], v29 offset:21504
ds_read_b64 v[154:155], v29 offset:22528
ds_read_b64 v[156:157], v29 offset:23552
v_pk_fma_f32 v[32:33], v[112:113], v[24:25], v[32:33] op_sel:[0,0,0] op_sel_hi:[1,0,1]
v_pk_fma_f32 v[34:35], v[114:115], v[24:25], v[34:35] op_sel:[0,0,0] op_sel_hi:[1,0,1]
v_pk_fma_f32 v[36:37], v[116:117], v[24:25], v[36:37] op_sel:[0,0,0] op_sel_hi:[1,0,1]
v_pk_fma_f32 v[38:39], v[118:119], v[24:25], v[38:39] op_sel:[0,0,0] op_sel_hi:[1,0,1]
v_pk_fma_f32 v[40:41], v[120:121], v[24:25], v[40:41] op_sel:[0,0,0] op_sel_hi:[1,0,1]
v_pk_fma_f32 v[42:43], v[122:123], v[24:25], v[42:43] op_sel:[0,0,0] op_sel_hi:[1,0,1]
v_pk_fma_f32 v[44:45], v[124:125], v[24:25], v[44:45] op_sel:[0,0,0] op_sel_hi:[1,0,1]
v_pk_fma_f32 v[46:47], v[126:127], v[24:25], v[46:47] op_sel:[0,0,0] op_sel_hi:[1,0,1]
s_waitcnt lgkmcnt(7)
ds_read_b64 v[158:159], v29 offset:24576
v_pk_fma_f32 v[32:33], v[128:129], v[26:27], v[32:33] op_sel:[0,0,0] op_sel_hi:[1,0,1]
v_pk_fma_f32 v[34:35], v[130:131], v[26:27], v[34:35] op_sel:[0,0,0] op_sel_hi:[1,0,1]
v_pk_fma_f32 v[36:37], v[132:133], v[26:27], v[36:37] op_sel:[0,0,0] op_sel_hi:[1,0,1]
v_pk_fma_f32 v[38:39], v[134:135], v[26:27], v[38:39] op_sel:[0,0,0] op_sel_hi:[1,0,1]
v_pk_fma_f32 v[40:41], v[136:137], v[26:27], v[40:41] op_sel:[0,0,0] op_sel_hi:[1,0,1]
v_pk_fma_f32 v[42:43], v[138:139], v[26:27], v[42:43] op_sel:[0,0,0] op_sel_hi:[1,0,1]
v_pk_fma_f32 v[44:45], v[140:141], v[26:27], v[44:45] op_sel:[0,0,0] op_sel_hi:[1,0,1]
v_pk_fma_f32 v[46:47], v[142:143], v[26:27], v[46:47] op_sel:[0,0,0] op_sel_hi:[1,0,1]
s_waitcnt lgkmcnt(0)
v_pk_fma_f32 v[32:33], v[144:145], v[26:27], v[32:33] op_sel:[0,1,0] op_sel_hi:[1,1,1]
v_pk_fma_f32 v[34:35], v[146:147], v[26:27], v[34:35] op_sel:[0,1,0] op_sel_hi:[1,1,1]
v_pk_fma_f32 v[36:37], v[148:149], v[26:27], v[36:37] op_sel:[0,1,0] op_sel_hi:[1,1,1]
v_pk_fma_f32 v[38:39], v[150:151], v[26:27], v[38:39] op_sel:[0,1,0] op_sel_hi:[1,1,1]
v_pk_fma_f32 v[40:41], v[152:153], v[26:27], v[40:41] op_sel:[0,1,0] op_sel_hi:[1,1,1]
v_pk_fma_f32 v[42:43], v[154:155], v[26:27], v[42:43] op_sel:[0,1,0] op_sel_hi:[1,1,1]
v_pk_fma_f32 v[44:45], v[156:157], v[26:27], v[44:45] op_sel:[0,1,0] op_sel_hi:[1,1,1]
v_pk_fma_f32 v[46:47], v[158:159], v[26:27], v[46:47] op_sel:[0,1,0] op_sel_hi:[1,1,1]
s_branch L_cj
L_c23:
s_cmp_eq_u32 s40, 3
s_cbranch_scc1 L_c3
s_waitcnt vmcnt(3)
v_perm_b32 v32, v116, v112, s47
v_perm_b32 v36, v116, v112, s48
v_perm_b32 v33, v124, v120, s47
v_perm_b32 v37, v124, v120, s48
v_perm_b32 v34, v132, v128, s47
v_perm_b32 v38, v132, v128, s48
v_perm_b32 v35, v140, v136, s47
v_perm_b32 v39, v140, v136, s48
v_perm_b32 v40, v117, v113, s47
v_perm_b32 v44, v117, v113, s48
v_perm_b32 v41, v125, v121, s47
v_perm_b32 v45, v125, v121, s48
v_perm_b32 v42, v133, v129, s47
v_perm_b32 v46, v133, v129, s48
v_perm_b32 v43, v141, v137, s47
v_perm_b32 v47, v141, v137, s48
v_mfma_f32_16x16x32_bf16 v[48:51], v[32:35], v[24:27], v[48:51]
v_mfma_f32_16x16x32_bf16 v[52:55], v[36:39], v[24:27], v[52:55]
v_perm_b32 v32, v118, v114, s47
v_perm_b32 v36, v118, v114, s48
v_perm_b32 v33, v126, v122, s47
v_perm_b32 v37, v126, v122, s48
v_perm_b32 v34, v134, v130, s47
v_perm_b32 v38, v134, v130, s48
v_perm_b32 v35, v142, v138, s47
v_perm_b32 v39, v142, v138, s48
v_mfma_f32_16x16x32_bf16 v[56:59], v[40:43], v[24:27], v[56:59]
v_mfma_f32_16x16x32_bf16 v[60:63], v[44:47], v[24:27], v[60:63]
v_perm_b32 v40, v119, v115, s47
v_perm_b32 v44, v119, v115, s48
v_perm_b32 v41, v127, v123, s47
v_perm_b32 v45, v127, v123, s48
v_perm_b32 v42, v135, v131, s47
v_perm_b32 v46, v135, v131, s48
v_perm_b32 v43, v143, v139, s47
v_perm_b32 v47, v143, v139, s48
v_mfma_f32_16x16x32_bf16 v[64:67], v[32:35], v[24:27], v[64:67]
v_mfma_f32_16x16x32_bf16 v[68:71], v[36:39], v[24:27], v[68:71]
s_waitcnt vmcnt(1)
v_perm_b32 v32, v148, v144, s47
v_perm_b32 v36, v148, v144, s48
v_perm_b32 v33, v156, v152, s47
v_perm_b32 v37, v156, v152, s48
v_perm_b32 v34, v164, v160, s47
v_perm_b32 v38, v164, v160, s48
v_perm_b32 v35, v172, v168, s47
v_perm_b32 v39, v172, v168, s48
v_mfma_f32_16x16x32_bf16 v[72:75], v[40:43], v[24:27], v[72:75]
v_mfma_f32_16x16x32_bf16 v[76:79], v[44:47], v[24:27], v[76:79]
v_perm_b32 v40, v149, v145, s47
v_perm_b32 v44, v149, v145, s48
v_perm_b32 v41, v157, v153, s47
v_perm_b32 v45, v157, v153, s48
v_perm_b32 v42, v165, v161, s47
v_perm_b32 v46, v165, v161, s48
v_perm_b32 v43, v173, v169, s47
v_perm_b32 v47, v173, v169, s48
v_mfma_f32_16x16x32_bf16 v[80:83], v[32:35], v[24:27], v[80:83]
v_mfma_f32_16x16x32_bf16 v[84:87], v[36:39], v[24:27], v[84:87]
ds_write_b64 v29, v[48:49] offset:0
ds_write_b64 v29, v[50:51] offset:512
ds_write_b64 v29, v[52:53] offset:1024
ds_write_b64 v29, v[54:55] offset:1536
v_perm_b32 v32, v150, v146, s47
v_perm_b32 v36, v150, v146, s48
v_perm_b32 v33, v158, v154, s47
v_perm_b32 v37, v158, v154, s48
v_perm_b32 v34, v166, v162, s47
v_perm_b32 v38, v166, v162, s48
v_perm_b32 v35, v174, v170, s47
v_perm_b32 v39, v174, v170, s48
v_mfma_f32_16x16x32_bf16 v[88:91], v[40:43], v[24:27], v[88:91]
v_mfma_f32_16x16x32_bf16 v[92:95], v[44:47], v[24:27], v[92:95]
ds_write_b64 v29, v[56:57] offset:2048
ds_write_b64 v29, v[58:59] offset:2560
ds_write_b64 v29, v[60:61] offset:3072
ds_write_b64 v29, v[62:63] offset:3584
v_perm_b32 v40, v151, v147, s47
v_perm_b32 v44, v151, v147, s48
v_perm_b32 v41, v159, v155, s47
v_perm_b32 v45, v159, v155, s48
v_perm_b32 v42, v167, v163, s47
v_perm_b32 v46, v167, v163, s48
v_perm_b32 v43, v175, v171, s47
v_perm_b32 v47, v175, v171, s48
v_mfma_f32_16x16x32_bf16 v[96:99], v[32:35], v[24:27], v[96:99]
v_mfma_f32_16x16x32_bf16 v[100:103], v[36:39], v[24:27], v[100:103]
ds_write_b64 v29, v[64:65] offset:4096
ds_write_b64 v29, v[66:67] offset:4608
ds_write_b64 v29, v[68:69] offset:5120
ds_write_b64 v29, v[70:71] offset:5632
v_mfma_f32_16x16x32_bf16 v[104:107], v[40:43], v[24:27], v[104:107]
v_mfma_f32_16x16x32_bf16 v[108:111], v[44:47], v[24:27], v[108:111]
ds_write_b64 v29, v[72:73] offset:6144
ds_write_b64 v29, v[74:75] offset:6656
ds_write_b64 v29, v[76:77] offset:7168
ds_write_b64 v29, v[78:79] offset:7680
ds_write_b64 v29, v[82:83] offset:8704
ds_write_b64 v29, v[86:87] offset:9728
ds_write_b64 v29, v[90:91] offset:10752
ds_write_b64 v29, v[94:95] offset:11776
s_nop 3
ds_write_b64 v29, v[98:99] offset:12800
ds_write_b64 v29, v[102:103] offset:13824
ds_write_b64 v29, v[106:107] offset:14848
ds_write_b64 v29, v[110:111] offset:15872
v_add_u32 v29, 33792, v253
s_waitcnt vmcnt(0)
s_mov_b64 exec, 1
ds_write_b32 v250, v240
s_mov_b64 exec, -1
s_waitcnt lgkmcnt(0)
s_barrier
ds_read_b32 v30, v251
ds_read_b64 v[16:17], v14 offset:0
ds_read_b64 v[18:19], v14 offset:512
ds_read_b64 v[20:21], v14 offset:1024
ds_read_b64 v[22:23], v14 offset:1536
ds_read_b64 v[112:113], v253 offset:8192
ds_read_b64 v[114:115], v253 offset:9216
ds_read_b64 v[116:117], v253 offset:10240
ds_read_b64 v[118:119], v253 offset:11264
ds_read_b64 v[120:121], v253 offset:12288
ds_read_b64 v[122:123], v253 offset:13312
ds_read_b64 v[124:125], v253 offset:14336
ds_read_b64 v[126:127], v253 offset:15360
s_waitcnt lgkmcnt(12)
v_readfirstlane_b32 s44, v30
s_nop 0
s_cmp_eq_u32 s44, 3
s_cselect_b32 s77, 1, 0
s_cbranch_scc0 L_nf2
buffer_load_dwordx3 v[228:230], v249, s[32:35], s73 offen sc1
buffer_load_dwordx3 v[232:234], v249, s[32:35], s74 offen sc1
buffer_load_dwordx3 v[236:238], v249, s[32:35], s75 offen sc1
buffer_load_dwordx4 v[184:187], v252, s[32:35], s53 offen offset:0 sc1
buffer_load_dwordx4 v[188:191], v252, s[32:35], s53 offen offset:1024 sc1
buffer_load_dwordx4 v[192:195], v252, s[32:35], s54 offen offset:0 sc1
buffer_load_dwordx4 v[196:199], v252, s[32:35], s54 offen offset:1024 sc1
buffer_load_dwordx4 v[200:203], v252, s[32:35], s55 offen offset:0 sc1
buffer_load_dwordx4 v[204:207], v252, s[32:35], s55 offen offset:1024 sc1
L_nf2:
s_waitcnt lgkmcnt(8)
ds_read_b64 v[128:129], v253 offset:25088
ds_read_b64 v[130:131], v253 offset:26112
ds_read_b64 v[132:133], v253 offset:27136
ds_read_b64 v[134:135], v253 offset:28160
ds_read_b64 v[136:137], v253 offset:29184
ds_read_b64 v[138:139], v253 offset:30208
ds_read_b64 v[140:141], v253 offset:31232
v_max3_f32 v8, v16, v18, v20
v_max_f32 v8, v8, v22
v_sub_f32 v24, v16, v8
v_sub_f32 v25, v18, v8
v_sub_f32 v26, v20, v8
v_sub_f32 v27, v22, v8
v_mul_f32 v24, s46, v24
v_mul_f32 v25, s46, v25
v_mul_f32 v26, s46, v26
v_mul_f32 v27, s46, v27
v_exp_f32 v24, v24
v_exp_f32 v25, v25
v_exp_f32 v26, v26
v_exp_f32 v27, v27
s_nop 0
v_mul_f32 v17, v24, v17
v_mul_f32 v19, v25, v19
v_mul_f32 v21, v26, v21
v_mul_f32 v23, v27, v23
v_add_f32 v17, v17, v19
v_add_f32 v21, v21, v23
v_add_f32 v9, v17, v21
v_pk_mul_f32 v[32:33], v[80:81], v[26:27] op_sel:[0,0] op_sel_hi:[1,0]
v_pk_mul_f32 v[34:35], v[84:85], v[26:27] op_sel:[0,0] op_sel_hi:[1,0]
v_pk_mul_f32 v[36:37], v[88:89], v[26:27] op_sel:[0,0] op_sel_hi:[1,0]
v_pk_mul_f32 v[38:39], v[92:93], v[26:27] op_sel:[0,0] op_sel_hi:[1,0]
v_pk_mul_f32 v[40:41], v[96:97], v[26:27] op_sel:[0,0] op_sel_hi:[1,0]
v_pk_mul_f32 v[42:43], v[100:101], v[26:27] op_sel:[0,0] op_sel_hi:[1,0]
v_pk_mul_f32 v[44:45], v[104:105], v[26:27] op_sel:[0,0] op_sel_hi:[1,0]
v_pk_mul_f32 v[46:47], v[108:109], v[26:27] op_sel:[0,0] op_sel_hi:[1,0]
s_waitcnt lgkmcnt(7)
ds_read_b64 v[142:143], v253 offset:32256
ds_read_b64 v[144:145], v29 offset:25088
ds_read_b64 v[146:147], v29 offset:26112
ds_read_b64 v[148:149], v29 offset:27136
ds_read_b64 v[150:151], v29 offset:28160
ds_read_b64 v[152:153], v29 offset:29184
ds_read_b64 v[154:155], v29 offset:30208
ds_read_b64 v[156:157], v29 offset:31232
v_pk_fma_f32 v[32:33], v[112:113], v[24:25], v[32:33] op_sel:[0,0,0] op_sel_hi:[1,0,1]
v_pk_fma_f32 v[34:35], v[114:115], v[24:25], v[34:35] op_sel:[0,0,0] op_sel_hi:[1,0,1]
v_pk_fma_f32 v[36:37], v[116:117], v[24:25], v[36:37] op_sel:[0,0,0] op_sel_hi:[1,0,1]
v_pk_fma_f32 v[38:39], v[118:119], v[24:25], v[38:39] op_sel:[0,0,0] op_sel_hi:[1,0,1]
v_pk_fma_f32 v[40:41], v[120:121], v[24:25], v[40:41] op_sel:[0,0,0] op_sel_hi:[1,0,1]
v_pk_fma_f32 v[42:43], v[122:123], v[24:25], v[42:43] op_sel:[0,0,0] op_sel_hi:[1,0,1]
v_pk_fma_f32 v[44:45], v[124:125], v[24:25], v[44:45] op_sel:[0,0,0] op_sel_hi:[1,0,1]
v_pk_fma_f32 v[46:47], v[126:127], v[24:25], v[46:47] op_sel:[0,0,0] op_sel_hi:[1,0,1]
s_waitcnt lgkmcnt(7)
ds_read_b64 v[158:159], v29 offset:32256
v_pk_fma_f32 v[32:33], v[128:129], v[24:25], v[32:33] op_sel:[0,1,0] op_sel_hi:[1,1,1]
v_pk_fma_f32 v[34:35], v[130:131], v[24:25], v[34:35] op_sel:[0,1,0] op_sel_hi:[1,1,1]
v_pk_fma_f32 v[36:37], v[132:133], v[24:25], v[36:37] op_sel:[0,1,0] op_sel_hi:[1,1,1]
v_pk_fma_f32 v[38:39], v[134:135], v[24:25], v[38:39] op_sel:[0,1,0] op_sel_hi:[1,1,1]
v_pk_fma_f32 v[40:41], v[136:137], v[24:25], v[40:41] op_sel:[0,1,0] op_sel_hi:[1,1,1]
v_pk_fma_f32 v[42:43], v[138:139], v[24:25], v[42:43] op_sel:[0,1,0] op_sel_hi:[1,1,1]
v_pk_fma_f32 v[44:45], v[140:141], v[24:25], v[44:45] op_sel:[0,1,0] op_sel_hi:[1,1,1]
v_pk_fma_f32 v[46:47], v[142:143], v[24:25], v[46:47] op_sel:[0,1,0] op_sel_hi:[1,1,1]
s_waitcnt lgkmcnt(0)
v_pk_fma_f32 v[32:33], v[144:145], v[26:27], v[32:33] op_sel:[0,1,0] op_sel_hi:[1,1,1]
v_pk_fma_f32 v[34:35], v[146:147], v[26:27], v[34:35] op_sel:[0,1,0] op_sel_hi:[1,1,1]
v_pk_fma_f32 v[36:37], v[148:149], v[26:27], v[36:37] op_sel:[0,1,0] op_sel_hi:[1,1,1]
v_pk_fma_f32 v[38:39], v[150:151], v[26:27], v[38:39] op_sel:[0,1,0] op_sel_hi:[1,1,1]
v_pk_fma_f32 v[40:41], v[152:153], v[26:27], v[40:41] op_sel:[0,1,0] op_sel_hi:[1,1,1]
v_pk_fma_f32 v[42:43], v[154:155], v[26:27], v[42:43] op_sel:[0,1,0] op_sel_hi:[1,1,1]
v_pk_fma_f32 v[44:45], v[156:157], v[26:27], v[44:45] op_sel:[0,1,0] op_sel_hi:[1,1,1]
v_pk_fma_f32 v[46:47], v[158:159], v[26:27], v[46:47] op_sel:[0,1,0] op_sel_hi:[1,1,1]
s_branch L_cj
L_c3:
s_waitcnt vmcnt(3)
v_perm_b32 v32, v116, v112, s47
v_perm_b32 v36, v116, v112, s48
v_perm_b32 v33, v124, v120, s47
v_perm_b32 v37, v124, v120, s48
v_perm_b32 v34, v132, v128, s47
v_perm_b32 v38, v132, v128, s48
v_perm_b32 v35, v140, v136, s47
v_perm_b32 v39, v140, v136, s48
v_perm_b32 v40, v117, v113, s47
v_perm_b32 v44, v117, v113, s48
v_perm_b32 v41, v125, v121, s47
v_perm_b32 v45, v125, v121, s48
v_perm_b32 v42, v133, v129, s47
v_perm_b32 v46, v133, v129, s48
v_perm_b32 v43, v141, v137, s47
v_perm_b32 v47, v141, v137, s48
v_mfma_f32_16x16x32_bf16 v[48:51], v[32:35], v[24:27], v[48:51]
v_mfma_f32_16x16x32_bf16 v[52:55], v[36:39], v[24:27], v[52:55]
v_perm_b32 v32, v118, v114, s47
v_perm_b32 v36, v118, v114, s48
v_perm_b32 v33, v126, v122, s47
v_perm_b32 v37, v126, v122, s48
v_perm_b32 v34, v134, v130, s47
v_perm_b32 v38, v134, v130, s48
v_perm_b32 v35, v142, v138, s47
v_perm_b32 v39, v142, v138, s48
v_mfma_f32_16x16x32_bf16 v[56:59], v[40:43], v[24:27], v[56:59]
v_mfma_f32_16x16x32_bf16 v[60:63], v[44:47], v[24:27], v[60:63]
v_perm_b32 v40, v119, v115, s47
v_perm_b32 v44, v119, v115, s48
v_perm_b32 v41, v127, v123, s47
v_perm_b32 v45, v127, v123, s48
v_perm_b32 v42, v135, v131, s47
v_perm_b32 v46, v135, v131, s48
v_perm_b32 v43, v143, v139, s47
v_perm_b32 v47, v143, v139, s48
v_mfma_f32_16x16x32_bf16 v[64:67], v[32:35], v[24:27], v[64:67]
v_mfma_f32_16x16x32_bf16 v[68:71], v[36:39], v[24:27], v[68:71]
s_waitcnt vmcnt(1)
v_perm_b32 v32, v148, v144, s47
v_perm_b32 v36, v148, v144, s48
v_perm_b32 v33, v156, v152, s47
v_perm_b32 v37, v156, v152, s48
v_perm_b32 v34, v164, v160, s47
v_perm_b32 v38, v164, v160, s48
v_perm_b32 v35, v172, v168, s47
v_perm_b32 v39, v172, v168, s48
v_mfma_f32_16x16x32_bf16 v[72:75], v[40:43], v[24:27], v[72:75]
v_mfma_f32_16x16x32_bf16 v[76:79], v[44:47], v[24:27], v[76:79]
v_perm_b32 v40, v149, v145, s47
v_perm_b32 v44, v149, v145, s48
v_perm_b32 v41, v157, v153, s47
v_perm_b32 v45, v157, v153, s48
v_perm_b32 v42, v165, v161, s47
v_perm_b32 v46, v165, v161, s48
v_perm_b32 v43, v173, v169, s47
v_perm_b32 v47, v173, v169, s48
v_mfma_f32_16x16x32_bf16 v[80:83], v[32:35], v[24:27], v[80:83]
v_mfma_f32_16x16x32_bf16 v[84:87], v[36:39], v[24:27], v[84:87]
ds_write_b64 v29, v[48:49] offset:0
ds_write_b64 v29, v[50:51] offset:512
ds_write_b64 v29, v[52:53] offset:1024
ds_write_b64 v29, v[54:55] offset:1536
v_perm_b32 v32, v150, v146, s47
v_perm_b32 v36, v150, v146, s48
v_perm_b32 v33, v158, v154, s47
v_perm_b32 v37, v158, v154, s48
v_perm_b32 v34, v166, v162, s47
v_perm_b32 v38, v166, v162, s48
v_perm_b32 v35, v174, v170, s47
v_perm_b32 v39, v174, v170, s48
v_mfma_f32_16x16x32_bf16 v[88:91], v[40:43], v[24:27], v[88:91]
v_mfma_f32_16x16x32_bf16 v[92:95], v[44:47], v[24:27], v[92:95]
ds_write_b64 v29, v[56:57] offset:2048
ds_write_b64 v29, v[58:59] offset:2560
ds_write_b64 v29, v[60:61] offset:3072
ds_write_b64 v29, v[62:63] offset:3584
v_perm_b32 v40, v151, v147, s47
v_perm_b32 v44, v151, v147, s48
v_perm_b32 v41, v159, v155, s47
v_perm_b32 v45, v159, v155, s48
v_perm_b32 v42, v167, v163, s47
v_perm_b32 v46, v167, v163, s48
v_perm_b32 v43, v175, v171, s47
v_perm_b32 v47, v175, v171, s48
v_mfma_f32_16x16x32_bf16 v[96:99], v[32:35], v[24:27], v[96:99]
v_mfma_f32_16x16x32_bf16 v[100:103], v[36:39], v[24:27], v[100:103]
ds_write_b64 v29, v[64:65] offset:4096
ds_write_b64 v29, v[66:67] offset:4608
ds_write_b64 v29, v[68:69] offset:5120
ds_write_b64 v29, v[70:71] offset:5632
v_mfma_f32_16x16x32_bf16 v[104:107], v[40:43], v[24:27], v[104:107]
v_mfma_f32_16x16x32_bf16 v[108:111], v[44:47], v[24:27], v[108:111]
ds_write_b64 v29, v[72:73] offset:6144
ds_write_b64 v29, v[74:75] offset:6656
ds_write_b64 v29, v[76:77] offset:7168
ds_write_b64 v29, v[78:79] offset:7680
ds_write_b64 v29, v[80:81] offset:8192
ds_write_b64 v29, v[84:85] offset:9216
ds_write_b64 v29, v[88:89] offset:10240
ds_write_b64 v29, v[92:93] offset:11264
s_nop 3
ds_write_b64 v29, v[96:97] offset:12288
ds_write_b64 v29, v[100:101] offset:13312
ds_write_b64 v29, v[104:105] offset:14336
ds_write_b64 v29, v[108:109] offset:15360
v_add_u32 v29, 33792, v253
s_waitcnt vmcnt(0)
s_mov_b64 exec, 1
ds_write_b32 v250, v240
s_mov_b64 exec, -1
s_waitcnt lgkmcnt(0)
s_barrier
ds_read_b32 v30, v251
ds_read_b64 v[16:17], v14 offset:0
ds_read_b64 v[18:19], v14 offset:512
ds_read_b64 v[20:21], v14 offset:1024
ds_read_b64 v[22:23], v14 offset:1536
ds_read_b64 v[112:113], v253 offset:8704
ds_read_b64 v[114:115], v253 offset:9728
ds_read_b64 v[116:117], v253 offset:10752
ds_read_b64 v[118:119], v253 offset:11776
ds_read_b64 v[120:121], v253 offset:12800
ds_read_b64 v[122:123], v253 offset:13824
ds_read_b64 v[124:125], v253 offset:14848
ds_read_b64 v[126:127], v253 offset:15872
s_waitcnt lgkmcnt(12)
v_readfirstlane_b32 s44, v30
s_nop 0
s_cmp_eq_u32 s44, 3
s_cselect_b32 s77, 1, 0
s_cbranch_scc0 L_nf3
buffer_load_dwordx3 v[228:230], v249, s[32:35], s73 offen sc1
buffer_load_dwordx3 v[232:234], v249, s[32:35], s74 offen sc1
buffer_load_dwordx3 v[236:238], v249, s[32:35], s75 offen sc1
buffer_load_dwordx4 v[184:187], v252, s[32:35], s53 offen offset:0 sc1
buffer_load_dwordx4 v[188:191], v252, s[32:35], s53 offen offset:1024 sc1
buffer_load_dwordx4 v[192:195], v252, s[32:35], s54 offen offset:0 sc1
buffer_load_dwordx4 v[196:199], v252, s[32:35], s54 offen offset:1024 sc1
buffer_load_dwordx4 v[200:203], v252, s[32:35], s55 offen offset:0 sc1
buffer_load_dwordx4 v[204:207], v252, s[32:35], s55 offen offset:1024 sc1
L_nf3:
s_waitcnt lgkmcnt(8)
ds_read_b64 v[128:129], v253 offset:25600
ds_read_b64 v[130:131], v253 offset:26624
ds_read_b64 v[132:133], v253 offset:27648
ds_read_b64 v[134:135], v253 offset:28672
ds_read_b64 v[136:137], v253 offset:29696
ds_read_b64 v[138:139], v253 offset:30720
ds_read_b64 v[140:141], v253 offset:31744
v_max3_f32 v8, v16, v18, v20
v_max_f32 v8, v8, v22
v_sub_f32 v24, v16, v8
v_sub_f32 v25, v18, v8
v_sub_f32 v26, v20, v8
v_sub_f32 v27, v22, v8
v_mul_f32 v24, s46, v24
v_mul_f32 v25, s46, v25
v_mul_f32 v26, s46, v26
v_mul_f32 v27, s46, v27
v_exp_f32 v24, v24
v_exp_f32 v25, v25
v_exp_f32 v26, v26
v_exp_f32 v27, v27
s_nop 0
v_mul_f32 v17, v24, v17
v_mul_f32 v19, v25, v19
v_mul_f32 v21, v26, v21
v_mul_f32 v23, v27, v23
v_add_f32 v17, v17, v19
v_add_f32 v21, v21, v23
v_add_f32 v9, v17, v21
v_pk_mul_f32 v[32:33], v[82:83], v[26:27] op_sel:[0,1] op_sel_hi:[1,1]
v_pk_mul_f32 v[34:35], v[86:87], v[26:27] op_sel:[0,1] op_sel_hi:[1,1]
v_pk_mul_f32 v[36:37], v[90:91], v[26:27] op_sel:[0,1] op_sel_hi:[1,1]
v_pk_mul_f32 v[38:39], v[94:95], v[26:27] op_sel:[0,1] op_sel_hi:[1,1]
v_pk_mul_f32 v[40:41], v[98:99], v[26:27] op_sel:[0,1] op_sel_hi:[1,1]
v_pk_mul_f32 v[42:43], v[102:103], v[26:27] op_sel:[0,1] op_sel_hi:[1,1]
v_pk_mul_f32 v[44:45], v[106:107], v[26:27] op_sel:[0,1] op_sel_hi:[1,1]
v_pk_mul_f32 v[46:47], v[110:111], v[26:27] op_sel:[0,1] op_sel_hi:[1,1]
s_waitcnt lgkmcnt(7)
ds_read_b64 v[142:143], v253 offset:32768
ds_read_b64 v[144:145], v29 offset:8704
ds_read_b64 v[146:147], v29 offset:9728
ds_read_b64 v[148:149], v29 offset:10752
ds_read_b64 v[150:151], v29 offset:11776
ds_read_b64 v[152:153], v29 offset:12800
ds_read_b64 v[154:155], v29 offset:13824
ds_read_b64 v[156:157], v29 offset:14848
v_pk_fma_f32 v[32:33], v[112:113], v[24:25], v[32:33] op_sel:[0,0,0] op_sel_hi:[1,0,1]
v_pk_fma_f32 v[34:35], v[114:115], v[24:25], v[34:35] op_sel:[0,0,0] op_sel_hi:[1,0,1]
v_pk_fma_f32 v[36:37], v[116:117], v[24:25], v[36:37] op_sel:[0,0,0] op_sel_hi:[1,0,1]
v_pk_fma_f32 v[38:39], v[118:119], v[24:25], v[38:39] op_sel:[0,0,0] op_sel_hi:[1,0,1]
v_pk_fma_f32 v[40:41], v[120:121], v[24:25], v[40:41] op_sel:[0,0,0] op_sel_hi:[1,0,1]
v_pk_fma_f32 v[42:43], v[122:123], v[24:25], v[42:43] op_sel:[0,0,0] op_sel_hi:[1,0,1]
v_pk_fma_f32 v[44:45], v[124:125], v[24:25], v[44:45] op_sel:[0,0,0] op_sel_hi:[1,0,1]
v_pk_fma_f32 v[46:47], v[126:127], v[24:25], v[46:47] op_sel:[0,0,0] op_sel_hi:[1,0,1]
s_waitcnt lgkmcnt(7)
ds_read_b64 v[158:159], v29 offset:15872
v_pk_fma_f32 v[32:33], v[128:129], v[24:25], v[32:33] op_sel:[0,1,0] op_sel_hi:[1,1,1]
v_pk_fma_f32 v[34:35], v[130:131], v[24:25], v[34:35] op_sel:[0,1,0] op_sel_hi:[1,1,1]
v_pk_fma_f32 v[36:37], v[132:133], v[24:25], v[36:37] op_sel:[0,1,0] op_sel_hi:[1,1,1]
v_pk_fma_f32 v[38:39], v[134:135], v[24:25], v[38:39] op_sel:[0,1,0] op_sel_hi:[1,1,1]
v_pk_fma_f32 v[40:41], v[136:137], v[24:25], v[40:41] op_sel:[0,1,0] op_sel_hi:[1,1,1]
v_pk_fma_f32 v[42:43], v[138:139], v[24:25], v[42:43] op_sel:[0,1,0] op_sel_hi:[1,1,1]
v_pk_fma_f32 v[44:45], v[140:141], v[24:25], v[44:45] op_sel:[0,1,0] op_sel_hi:[1,1,1]
v_pk_fma_f32 v[46:47], v[142:143], v[24:25], v[46:47] op_sel:[0,1,0] op_sel_hi:[1,1,1]
s_waitcnt lgkmcnt(0)
v_pk_fma_f32 v[32:33], v[144:145], v[26:27], v[32:33] op_sel:[0,0,0] op_sel_hi:[1,0,1]
v_pk_fma_f32 v[34:35], v[146:147], v[26:27], v[34:35] op_sel:[0,0,0] op_sel_hi:[1,0,1]
v_pk_fma_f32 v[36:37], v[148:149], v[26:27], v[36:37] op_sel:[0,0,0] op_sel_hi:[1,0,1]
v_pk_fma_f32 v[38:39], v[150:151], v[26:27], v[38:39] op_sel:[0,0,0] op_sel_hi:[1,0,1]
v_pk_fma_f32 v[40:41], v[152:153], v[26:27], v[40:41] op_sel:[0,0,0] op_sel_hi:[1,0,1]
v_pk_fma_f32 v[42:43], v[154:155], v[26:27], v[42:43] op_sel:[0,0,0] op_sel_hi:[1,0,1]
v_pk_fma_f32 v[44:45], v[156:157], v[26:27], v[44:45] op_sel:[0,0,0] op_sel_hi:[1,0,1]
v_pk_fma_f32 v[46:47], v[158:159], v[26:27], v[46:47] op_sel:[0,0,0] op_sel_hi:[1,0,1]
L_cj:
v_max3_f32 v12, |v32|, |v33|, |v34|
v_max3_f32 v13, |v35|, |v36|, |v37|
v_max3_f32 v12, v12, |v38|, |v39|
v_max3_f32 v13, v13, |v40|, |v41|
v_max3_f32 v12, v12, |v42|, |v43|
v_max3_f32 v13, v13, |v44|, |v45|
v_max3_f32 v12, v12, |v46|, |v47|
v_max_f32 v12, v12, v13
v_frexp_exp_i32_f32 v12, v12
s_movk_i32 s49, 0xff
v_max_i32 v12, 0xffffff9c, v12
v_sub_u32 v13, 15, v12
v_add_u32 v12, 0x7f, v12
v_ldexp_f32 v14, 1.0, v13
v_bfi_b32 v9, s49, v12, v9
v_pk_mul_f32 v[32:33], v[32:33], v[14:15] op_sel:[0,0] op_sel_hi:[1,0]
v_pk_mul_f32 v[34:35], v[34:35], v[14:15] op_sel:[0,0] op_sel_hi:[1,0]
v_pk_mul_f32 v[36:37], v[36:37], v[14:15] op_sel:[0,0] op_sel_hi:[1,0]
v_pk_mul_f32 v[38:39], v[38:39], v[14:15] op_sel:[0,0] op_sel_hi:[1,0]
v_pk_mul_f32 v[40:41], v[40:41], v[14:15] op_sel:[0,0] op_sel_hi:[1,0]
v_pk_mul_f32 v[42:43], v[42:43], v[14:15] op_sel:[0,0] op_sel_hi:[1,0]
v_pk_mul_f32 v[44:45], v[44:45], v[14:15] op_sel:[0,0] op_sel_hi:[1,0]
v_pk_mul_f32 v[46:47], v[46:47], v[14:15] op_sel:[0,0] op_sel_hi:[1,0]
v_cvt_pk_f16_f32 v176, v32, v33
v_cvt_pk_f16_f32 v177, v34, v35
v_cvt_pk_f16_f32 v178, v36, v37
v_cvt_pk_f16_f32 v179, v38, v39
v_cvt_pk_f16_f32 v180, v40, v41
v_cvt_pk_f16_f32 v181, v42, v43
v_cvt_pk_f16_f32 v182, v44, v45
v_cvt_pk_f16_f32 v183, v46, v47
s_cmp_lg_u32 s77, 0
s_cbranch_scc1 L_last
buffer_store_dwordx4 v[176:179], v252, s[32:35], s52 offen offset:0 sc1
buffer_store_dwordx4 v[180:183], v252, s[32:35], s52 offen offset:1024 sc1
v_add3_u32 v10, s57, v8, v9
v_add3_u32 v10, v10, v176, v177
v_add3_u32 v10, v10, v178, v179
v_add3_u32 v10, v10, v180, v181
v_add3_u32 v10, v10, v182, v183
buffer_store_dwordx3 v[8:10], v249, s[32:35], s72 offen sc1
s_branch L_done
L_last:
v_mov_b32 v224, v8
v_mov_b32 v225, v9
L_chk:
s_waitcnt vmcnt(6)
v_max3_f32 v8, v224, v228, v232
v_max_f32 v8, v8, v236
v_sub_f32 v24, v224, v8
v_sub_f32 v25, v228, v8
v_sub_f32 v26, v232, v8
v_sub_f32 v27, v236, v8
v_mul_f32 v24, s46, v24
v_mul_f32 v25, s46, v25
v_mul_f32 v26, s46, v26
v_mul_f32 v27, s46, v27
v_exp_f32 v24, v24
v_exp_f32 v25, v25
v_exp_f32 v26, v26
v_exp_f32 v27, v27
s_nop 0
v_mul_f32 v16, v24, v225
v_mul_f32 v17, v25, v229
v_mul_f32 v18, v26, v233
v_mul_f32 v19, v27, v237
v_add_f32 v16, v16, v17
v_add_f32 v18, v18, v19
v_add_f32 v9, v16, v18
v_rcp_f32 v12, v9
v_and_b32 v20, 0xff, v225
v_and_b32 v21, 0xff, v229
v_and_b32 v22, 0xff, v233
v_and_b32 v23, 0xff, v237
v_mul_f32 v24, v24, v12
v_mul_f32 v25, v25, v12
v_mul_f32 v26, v26, v12
v_mul_f32 v27, v27, v12
v_add_u32 v20, 0xffffff72, v20
v_add_u32 v21, 0xffffff72, v21
v_add_u32 v22, 0xffffff72, v22
v_add_u32 v23, 0xffffff72, v23
v_ldexp_f32 v24, v24, v20
v_ldexp_f32 v25, v25, v21
v_ldexp_f32 v26, v26, v22
v_ldexp_f32 v27, v27, v23
s_waitcnt vmcnt(0)
v_add3_u32 v242, s57, v184, v185
v_add3_u32 v243, s57, v192, v193
v_add3_u32 v241, s57, v200, v201
v_add3_u32 v242, v242, v186, v187
v_add3_u32 v243, v243, v194, v195
v_add3_u32 v241, v241, v202, v203
v_add3_u32 v242, v242, v188, v189
v_add3_u32 v243, v243, v196, v197
v_add3_u32 v241, v241, v204, v205
v_add3_u32 v242, v242, v190, v191
v_add3_u32 v243, v243, v198, v199
v_add3_u32 v241, v241, v206, v207
v_add3_u32 v242, v242, v228, v229
v_add3_u32 v243, v243, v232, v233
v_add3_u32 v241, v241, v236, v237
v_xor_b32 v242, v242, v230
v_xor_b32 v243, v243, v234
v_xor_b32 v241, v241, v238
v_or3_b32 v242, v242, v243, v241
v_cmp_ne_u32 vcc, 0, v242
s_cbranch_vccz L_have
s_sub_u32 s79, s79, 1
s_cmp_eq_u32 s79, 0
s_cbranch_scc1 L_have
buffer_load_dwordx3 v[228:230], v249, s[32:35], s73 offen sc1
buffer_load_dwordx3 v[232:234], v249, s[32:35], s74 offen sc1
buffer_load_dwordx3 v[236:238], v249, s[32:35], s75 offen sc1
buffer_load_dwordx4 v[184:187], v252, s[32:35], s53 offen offset:0 sc1
buffer_load_dwordx4 v[188:191], v252, s[32:35], s53 offen offset:1024 sc1
buffer_load_dwordx4 v[192:195], v252, s[32:35], s54 offen offset:0 sc1
buffer_load_dwordx4 v[196:199], v252, s[32:35], s54 offen offset:1024 sc1
buffer_load_dwordx4 v[200:203], v252, s[32:35], s55 offen offset:0 sc1
buffer_load_dwordx4 v[204:207], v252, s[32:35], s55 offen offset:1024 sc1
s_branch L_chk
L_have:
v_fma_mix_f32 v112, v176, v24, 0 op_sel:[0,0,0] op_sel_hi:[1,0,0]
v_fma_mix_f32 v113, v177, v24, 0 op_sel:[0,0,0] op_sel_hi:[1,0,0]
v_fma_mix_f32 v114, v178, v24, 0 op_sel:[0,0,0] op_sel_hi:[1,0,0]
v_fma_mix_f32 v115, v179, v24, 0 op_sel:[0,0,0] op_sel_hi:[1,0,0]
v_fma_mix_f32 v116, v180, v24, 0 op_sel:[0,0,0] op_sel_hi:[1,0,0]
v_fma_mix_f32 v117, v181, v24, 0 op_sel:[0,0,0] op_sel_hi:[1,0,0]
v_fma_mix_f32 v118, v182, v24, 0 op_sel:[0,0,0] op_sel_hi:[1,0,0]
v_fma_mix_f32 v119, v183, v24, 0 op_sel:[0,0,0] op_sel_hi:[1,0,0]
v_fma_mix_f32 v120, v184, v25, 0 op_sel:[0,0,0] op_sel_hi:[1,0,0]
v_fma_mix_f32 v121, v185, v25, 0 op_sel:[0,0,0] op_sel_hi:[1,0,0]
v_fma_mix_f32 v122, v186, v25, 0 op_sel:[0,0,0] op_sel_hi:[1,0,0]
v_fma_mix_f32 v123, v187, v25, 0 op_sel:[0,0,0] op_sel_hi:[1,0,0]
v_fma_mix_f32 v124, v188, v25, 0 op_sel:[0,0,0] op_sel_hi:[1,0,0]
v_fma_mix_f32 v125, v189, v25, 0 op_sel:[0,0,0] op_sel_hi:[1,0,0]
v_fma_mix_f32 v126, v190, v25, 0 op_sel:[0,0,0] op_sel_hi:[1,0,0]
v_fma_mix_f32 v127, v191, v25, 0 op_sel:[0,0,0] op_sel_hi:[1,0,0]
v_fma_mix_f32 v128, v192, v26, 0 op_sel:[0,0,0] op_sel_hi:[1,0,0]
v_fma_mix_f32 v129, v193, v26, 0 op_sel:[0,0,0] op_sel_hi:[1,0,0]
v_fma_mix_f32 v130, v194, v26, 0 op_sel:[0,0,0] op_sel_hi:[1,0,0]
v_fma_mix_f32 v131, v195, v26, 0 op_sel:[0,0,0] op_sel_hi:[1,0,0]
v_fma_mix_f32 v132, v196, v26, 0 op_sel:[0,0,0] op_sel_hi:[1,0,0]
v_fma_mix_f32 v133, v197, v26, 0 op_sel:[0,0,0] op_sel_hi:[1,0,0]
v_fma_mix_f32 v134, v198, v26, 0 op_sel:[0,0,0] op_sel_hi:[1,0,0]
v_fma_mix_f32 v135, v199, v26, 0 op_sel:[0,0,0] op_sel_hi:[1,0,0]
v_fma_mix_f32 v136, v200, v27, 0 op_sel:[0,0,0] op_sel_hi:[1,0,0]
v_fma_mix_f32 v137, v201, v27, 0 op_sel:[0,0,0] op_sel_hi:[1,0,0]
v_fma_mix_f32 v138, v202, v27, 0 op_sel:[0,0,0] op_sel_hi:[1,0,0]
v_fma_mix_f32 v139, v203, v27, 0 op_sel:[0,0,0] op_sel_hi:[1,0,0]
v_fma_mix_f32 v140, v204, v27, 0 op_sel:[0,0,0] op_sel_hi:[1,0,0]
v_fma_mix_f32 v141, v205, v27, 0 op_sel:[0,0,0] op_sel_hi:[1,0,0]
v_fma_mix_f32 v142, v206, v27, 0 op_sel:[0,0,0] op_sel_hi:[1,0,0]
v_fma_mix_f32 v143, v207, v27, 0 op_sel:[0,0,0] op_sel_hi:[1,0,0]
v_pk_add_f32 v[112:113], v[112:113], v[120:121]
v_pk_add_f32 v[114:115], v[114:115], v[122:123]
v_pk_add_f32 v[116:117], v[116:117], v[124:125]
v_pk_add_f32 v[118:119], v[118:119], v[126:127]
v_pk_add_f32 v[128:129], v[128:129], v[136:137]
v_pk_add_f32 v[130:131], v[130:131], v[138:139]
v_pk_add_f32 v[132:133], v[132:133], v[140:141]
v_pk_add_f32 v[134:135], v[134:135], v[142:143]
v_pk_add_f32 v[112:113], v[112:113], v[128:129]
v_pk_add_f32 v[114:115], v[114:115], v[130:131]
v_pk_add_f32 v[116:117], v[116:117], v[132:133]
v_pk_add_f32 v[118:119], v[118:119], v[134:135]
v_cvt_pk_bf16_f32 v144, v112, v113
v_cvt_pk_bf16_f32 v145, v114, v115
v_cvt_pk_bf16_f32 v146, v116, v117
v_cvt_pk_bf16_f32 v147, v118, v119
buffer_store_dwordx4 v[144:147], v254, s[28:31], s56 offen offset:0
v_fma_mix_f32 v112, v176, v24, 0 op_sel:[1,0,0] op_sel_hi:[1,0,0]
v_fma_mix_f32 v113, v177, v24, 0 op_sel:[1,0,0] op_sel_hi:[1,0,0]
v_fma_mix_f32 v114, v178, v24, 0 op_sel:[1,0,0] op_sel_hi:[1,0,0]
v_fma_mix_f32 v115, v179, v24, 0 op_sel:[1,0,0] op_sel_hi:[1,0,0]
v_fma_mix_f32 v116, v180, v24, 0 op_sel:[1,0,0] op_sel_hi:[1,0,0]
v_fma_mix_f32 v117, v181, v24, 0 op_sel:[1,0,0] op_sel_hi:[1,0,0]
v_fma_mix_f32 v118, v182, v24, 0 op_sel:[1,0,0] op_sel_hi:[1,0,0]
v_fma_mix_f32 v119, v183, v24, 0 op_sel:[1,0,0] op_sel_hi:[1,0,0]
v_fma_mix_f32 v120, v184, v25, 0 op_sel:[1,0,0] op_sel_hi:[1,0,0]
v_fma_mix_f32 v121, v185, v25, 0 op_sel:[1,0,0] op_sel_hi:[1,0,0]
v_fma_mix_f32 v122, v186, v25, 0 op_sel:[1,0,0] op_sel_hi:[1,0,0]
v_fma_mix_f32 v123, v187, v25, 0 op_sel:[1,0,0] op_sel_hi:[1,0,0]
v_fma_mix_f32 v124, v188, v25, 0 op_sel:[1,0,0] op_sel_hi:[1,0,0]
v_fma_mix_f32 v125, v189, v25, 0 op_sel:[1,0,0] op_sel_hi:[1,0,0]
v_fma_mix_f32 v126, v190, v25, 0 op_sel:[1,0,0] op_sel_hi:[1,0,0]
v_fma_mix_f32 v127, v191, v25, 0 op_sel:[1,0,0] op_sel_hi:[1,0,0]
v_fma_mix_f32 v128, v192, v26, 0 op_sel:[1,0,0] op_sel_hi:[1,0,0]
v_fma_mix_f32 v129, v193, v26, 0 op_sel:[1,0,0] op_sel_hi:[1,0,0]
v_fma_mix_f32 v130, v194, v26, 0 op_sel:[1,0,0] op_sel_hi:[1,0,0]
v_fma_mix_f32 v131, v195, v26, 0 op_sel:[1,0,0] op_sel_hi:[1,0,0]
v_fma_mix_f32 v132, v196, v26, 0 op_sel:[1,0,0] op_sel_hi:[1,0,0]
v_fma_mix_f32 v133, v197, v26, 0 op_sel:[1,0,0] op_sel_hi:[1,0,0]
v_fma_mix_f32 v134, v198, v26, 0 op_sel:[1,0,0] op_sel_hi:[1,0,0]
v_fma_mix_f32 v135, v199, v26, 0 op_sel:[1,0,0] op_sel_hi:[1,0,0]
v_fma_mix_f32 v136, v200, v27, 0 op_sel:[1,0,0] op_sel_hi:[1,0,0]
v_fma_mix_f32 v137, v201, v27, 0 op_sel:[1,0,0] op_sel_hi:[1,0,0]
v_fma_mix_f32 v138, v202, v27, 0 op_sel:[1,0,0] op_sel_hi:[1,0,0]
v_fma_mix_f32 v139, v203, v27, 0 op_sel:[1,0,0] op_sel_hi:[1,0,0]
v_fma_mix_f32 v140, v204, v27, 0 op_sel:[1,0,0] op_sel_hi:[1,0,0]
v_fma_mix_f32 v141, v205, v27, 0 op_sel:[1,0,0] op_sel_hi:[1,0,0]
v_fma_mix_f32 v142, v206, v27, 0 op_sel:[1,0,0] op_sel_hi:[1,0,0]
v_fma_mix_f32 v143, v207, v27, 0 op_sel:[1,0,0] op_sel_hi:[1,0,0]
v_pk_add_f32 v[112:113], v[112:113], v[120:121]
v_pk_add_f32 v[114:115], v[114:115], v[122:123]
v_pk_add_f32 v[116:117], v[116:117], v[124:125]
v_pk_add_f32 v[118:119], v[118:119], v[126:127]
v_pk_add_f32 v[128:129], v[128:129], v[136:137]
v_pk_add_f32 v[130:131], v[130:131], v[138:139]
v_pk_add_f32 v[132:133], v[132:133], v[140:141]
v_pk_add_f32 v[134:135], v[134:135], v[142:143]
v_pk_add_f32 v[112:113], v[112:113], v[128:129]
v_pk_add_f32 v[114:115], v[114:115], v[130:131]
v_pk_add_f32 v[116:117], v[116:117], v[132:133]
v_pk_add_f32 v[118:119], v[118:119], v[134:135]
v_cvt_pk_bf16_f32 v148, v112, v113
v_cvt_pk_bf16_f32 v149, v114, v115
v_cvt_pk_bf16_f32 v150, v116, v117
v_cvt_pk_bf16_f32 v151, v118, v119
buffer_store_dwordx4 v[148:151], v254, s[28:31], s56 offen offset:16
L_outdone:
s_cmp_lg_u32 s40, 0
s_cbranch_scc1 L_done
v_mov_b32 v12, s81
s_cmp_eq_u32 s41, 0
s_cselect_b32 s49, 3, 1
v_writelane_b32 v12, s57, 0
s_mov_b32 exec_lo, s49
s_mov_b32 exec_hi, 0
buffer_store_dword v12, v246, s[32:35], 0 offen sc1
s_mov_b64 exec, -1
L_done:
L_end:
s_endpgm
.section .rodata,"a"
.p2align 6
.amdhsa_kernel standalone__gqa_softmax__sampling_kernel
.amdhsa_next_free_vgpr 288
.amdhsa_next_free_sgpr 88
.amdhsa_accum_offset 256
.amdhsa_group_segment_fixed_size 0
.amdhsa_kernarg_size 48
.amdhsa_user_sgpr_count 2
.amdhsa_user_sgpr_kernarg_segment_ptr 1
.amdhsa_system_sgpr_workgroup_id_x 1
.amdhsa_float_denorm_mode_32 3
.end_amdhsa_kernel
```
